```python
import torch

def _softmax(x, axis=-1):
    return torch.softmax(x, dim=axis)
def _gelu(x):
    return torch.nn.functional.gelu(x, approximate="tanh")
def _silu(x):
    return torch.nn.functional.silu(x)
def _sigmoid(x):
    return torch.sigmoid(x)
def _layernorm(x, axis=-1, eps=1e-5):
    m = x.mean(dim=axis, keepdim=True)
    v = x.var(dim=axis, keepdim=True, unbiased=False)
    return (x - m) / torch.sqrt(v + eps)
def _scatter_add(tgt, idx, src, axis=0):
    return tgt.clone().index_add_(axis, idx, src)
def _segment_sum(src, seg, n):
    out = torch.zeros((n,) + src.shape[1:], dtype=src.dtype)
    return out.index_add_(0, seg, src)
def _pad(x, pw):
    flat = tuple(v for pair in reversed(pw) for v in pair)
    return torch.nn.functional.pad(x, flat)

kernel_name = 'recurrent_scan__gqa_block_cached__mixer_token_mlp__decode'

def setup_inputs():

    _w = (lambda a: (lambda t: t.to(torch.bfloat16) if t.is_floating_point() else t)(torch.as_tensor(a)))
    def _A_setup():
        B, Sq, D = 8, 1, 640
        Hq, Hkv, Sk, Dh = 32, 32, 4096, 128
        assert Hq % Hkv == 0, (Hq, Hkv)
        return {
            "x": _w((lambda *s: torch.randn(*s, dtype=torch.bfloat16) * 0.4)(B, Sq, D)),
            "k_cache": _w((lambda *s: torch.randn(*s, dtype=torch.bfloat16) * 1.6)(B, Hkv, Sk, Dh)),
            "v_cache": _w((lambda *s: torch.randn(*s, dtype=torch.bfloat16) * 1.6)(B, Hkv, Sk, Dh)),
            "wq": _w((lambda *s: torch.randn(*s, dtype=torch.bfloat16) * 1.6)(D, Hq * Dh) * (D ** -0.5)),
            "wo": _w((lambda *s: torch.randn(*s, dtype=torch.bfloat16) * 1.6)(Hq * Dh, D) * ((Hq * Dh) ** -0.5)),
        }
    _A_in = _A_setup()

    def _B_setup():
        B, S, D, F = 8, 1, 640, 1728
        return {
            "x": _w((lambda *s: torch.randn(*s, dtype=torch.bfloat16) * 0.4)(B, S, D)),
            "w1": _w((lambda *s: torch.randn(*s, dtype=torch.bfloat16) * 1.6)(S, F) * (S ** -0.5)),
            "b1": _w((lambda *s: torch.randn(*s, dtype=torch.bfloat16) * 1.6)(F) * 0.02),
            "w2": _w((lambda *s: torch.randn(*s, dtype=torch.bfloat16) * 1.6)(F, S) * (F ** -0.5)),
            "b2": _w((lambda *s: torch.randn(*s, dtype=torch.bfloat16) * 1.6)(S) * 0.02),
        }
    _B_in = _B_setup()

    return {
        "A_x": _A_in["x"],
        "A_k_cache": _A_in["k_cache"],
        "A_v_cache": _A_in["v_cache"],
        "A_wq": _A_in["wq"],
        "A_wo": _A_in["wo"],
        "B_x": _B_in["x"],
        "B_w1": _B_in["w1"],
        "B_b1": _B_in["b1"],
        "B_w2": _B_in["w2"],
        "B_b2": _B_in["b2"],
    }

def reference(A_x, A_k_cache, A_v_cache, A_wq, A_wo, B_x, B_w1, B_b1, B_w2, B_b2):
    def _A_ref(x, k_cache, v_cache, wq, wo):
        B, Sq, D = x.shape
        Hq, Dh = 32, 128
        Hkv = k_cache.shape[1]
        rep = Hq // Hkv
        q = (lambda x, *d: x.permute(*d))((x @ wq).reshape(B, Sq, Hq, Dh), 0, 2, 1, 3)
        k = (lambda x, n, axis: torch.repeat_interleave(x, n, dim=axis))(k_cache, rep, axis=1)
        v = (lambda x, n, axis: torch.repeat_interleave(x, n, dim=axis))(v_cache, rep, axis=1)
        scores = torch.einsum("bhqd,bhkd->bhqk", q, k) * (Dh ** -0.5)
        p = _softmax(scores, axis=-1)
        o = torch.einsum("bhqk,bhkd->bhqd", p, v)
        return (lambda x, *d: x.permute(*d))(o, 0, 2, 1, 3).reshape(B, Sq, Hq * Dh) @ wo

    def _B_ref(x, w1, b1, w2, b2):
        B, S, D = x.shape
        h = _layernorm(x, axis=-1)
        u = torch.einsum("bsd,sf->bdf", h, w1) + b1
        u = _gelu(u)
        y = torch.einsum("bdf,fs->bds", u, w2) + b2
        return (lambda x, *d: x.permute(*d))(y, 0, 2, 1)

    x = A_x
    xn = _layernorm(x, axis=-1)
    s = _A_ref(xn, A_k_cache, A_v_cache, A_wq, A_wo)
    g = _silu(_B_ref(xn, B_w1, B_b1, B_w2, B_b2))
    return x + s * g
```

```asm
; @launch grid=(256,1,1) block=(640,1,1) lds=156736
.amdgcn_target "amdgcn-amd-amdhsa--gfx950"
.text
.globl recurrent_scan__gqa_block_cached__mixer_token_mlp__decode_kernel
.p2align 8
.type recurrent_scan__gqa_block_cached__mixer_token_mlp__decode_kernel,@function
recurrent_scan__gqa_block_cached__mixer_token_mlp__decode_kernel:
  s_load_dwordx4 s[4:7], s[0:1], 8
  s_cmp_ge_u32 s2, 256
  s_cbranch_scc1 L_end
  v_lshrrev_b32 v1, 6, v0
  s_and_b32 s3, s2, 7
  s_lshr_b32 s36, s2, 3
  v_readfirstlane_b32 s34, v1
  s_and_b32 s37, s36, 3
  s_lshl_b32 s3, s3, 2
  s_add_u32 s37, s37, s3
  s_lshr_b32 s36, s36, 2
  s_lshl_b32 s38, s36, 5
  s_add_u32 s38, s38, s37
  s_cmp_eq_u32 s34, 0
  s_cbranch_scc1 L_loader
  s_load_dwordx16 s[8:23], s[0:1], 0
  s_load_dwordx8 s[24:31], s[0:1], 64
  s_load_dwordx2 s[32:33], s[0:1], 96
  s_sub_u32 s35, s34, 2
  v_and_b32 v1, 63, v0
  v_lshrrev_b32 v2, 4, v1
  v_and_b32 v3, 15, v1
  s_cmp_eq_u32 s34, 1
  s_barrier
  s_cbranch_scc1 L_ln
  s_branch L_worker2
L_loader:
  s_setprio 3
  v_lshrrev_b32 v2, 4, v0
  v_and_b32 v3, 15, v0
  v_xor_b32 v3, v3, v2
  v_lshlrev_b32 v2, 8, v2
  v_lshl_add_u32 v4, v3, 4, v2
  v_xor_b32 v5, 64, v4
  v_xor_b32 v6, 0x80, v4
  v_xor_b32 v7, 0xc0, v4
  v_lshlrev_b32 v10, 2, v0
  v_add_u32 v10, 151808, v10
  v_mov_b32 v9, 0
  ds_write_b32 v10, v9
  s_lshl_b32 s39, s38, 20
  s_mov_b32 s42, 0x100000
  s_mov_b32 s43, 0x20000
  s_mov_b32 s45, 0
  s_mov_b32 m0, 0
  v_mov_b32 v10, 151808
  v_mov_b32 v8, 0
  v_mov_b32 v12, 0
  v_mov_b32 v11, 151872
  s_mov_b32 s44, 0
  s_mov_b32 s50, 0
  s_mov_b32 s51, 0
  s_waitcnt lgkmcnt(0)
  s_add_u32 s40, s4, s39
  s_addc_u32 s41, s5, 0
  s_add_u32 s6, s6, s39
  s_addc_u32 s7, s7, 0
  buffer_load_dwordx4 v4, s[40:43], s45 offen offset:0 nt lds
  buffer_load_dwordx4 v5, s[40:43], s45 offen offset:1024 nt lds
  buffer_load_dwordx4 v6, s[40:43], s45 offen offset:2048 nt lds
  buffer_load_dwordx4 v7, s[40:43], s45 offen offset:3072 nt lds
  s_movk_i32 s45, 0x1000
  s_mov_b32 m0, s45
  s_mov_b32 s50, 1
  s_barrier
L_ldb2:
  s_waitcnt vmcnt(20)
  buffer_load_dwordx4 v4, s[40:43], s45 offen offset:0 nt lds
  s_add_i32 s47, s50, -5
  s_max_i32 s51, s51, s47
  s_mov_b64 exec, 1
  v_mov_b32 v9, s51
  ds_write_b32 v10, v9 offset:0
  s_mov_b64 exec, -1
  s_waitcnt vmcnt(20)
  buffer_load_dwordx4 v5, s[40:43], s45 offen offset:1024 nt lds
  ds_read_b32 v8, v11
  ds_read_b32 v12, v10 offset:20
  s_waitcnt vmcnt(20)
  buffer_load_dwordx4 v6, s[40:43], s45 offen offset:2048 nt lds
  s_waitcnt vmcnt(20)
  buffer_load_dwordx4 v7, s[40:43], s45 offen offset:3072 nt lds
  s_add_u32 s45, s45, 0x1000
  s_and_b32 m0, s45, 0x1ffff
  s_add_u32 s50, s50, 1
  s_and_b32 s47, s50, 3
  s_cbranch_scc1 L_ldb2
L_ld_bot:
  s_add_u32 s44, s44, 1
  s_cmp_lg_u32 s44, 64
  s_cbranch_scc1 L_ld_nosw
  s_mov_b32 s40, s6
  s_mov_b32 s41, s7
  s_mov_b32 s45, 0
L_ld_nosw:
  s_cmp_ge_u32 s44, 128
  s_cbranch_scc1 L_ld_drain
L_ld:
  s_waitcnt lgkmcnt(0)
  v_readfirstlane_b32 s46, v8
  v_readfirstlane_b32 s49, v12
  s_lshr_b32 s47, s44, 3
  s_cmp_ge_u32 s46, s47
  s_cbranch_scc1 L_ld_go
  s_sleep 1
  ds_read_b32 v8, v11
  s_branch L_ld
L_ld_go:
  s_add_u32 s47, s44, 1
  s_and_b32 s47, s47, 7
  s_lshl_b32 s47, s47, 2
  s_add_u32 s47, s47, 151872
  v_mov_b32 v11, s47
  s_cmp_eq_u32 s49, 0
  s_cbranch_scc1 L_ldb2
  s_xor_b32 s49, s49, 2
  s_cmp_ge_u32 s49, 3
  s_cbranch_scc1 L_tr_1
  s_cmp_ge_u32 s49, 1
  s_cbranch_scc1 L_tr_2
  s_branch L_ldb0
L_tr_2:
  s_cmp_ge_u32 s49, 2
  s_cbranch_scc1 L_ldb2
  s_branch L_ldb1
L_tr_1:
  s_cmp_ge_u32 s49, 5
  s_cbranch_scc1 L_tr_4
  s_cmp_ge_u32 s49, 4
  s_cbranch_scc1 L_ldb4
  s_branch L_ldb3
L_tr_4:
  s_cmp_ge_u32 s49, 6
  s_cbranch_scc1 L_ldb6
  s_branch L_ldb5
L_ldb0:
  s_waitcnt vmcnt(18)
  buffer_load_dwordx4 v4, s[40:43], s45 offen offset:0 nt lds
  s_waitcnt vmcnt(18)
  buffer_load_dwordx4 v5, s[40:43], s45 offen offset:1024 nt lds
  ds_read_b32 v8, v11
  ds_read_b32 v12, v10 offset:20
  s_waitcnt vmcnt(18)
  buffer_load_dwordx4 v6, s[40:43], s45 offen offset:2048 nt lds
  s_add_i32 s47, s50, -4
  s_max_i32 s51, s51, s47
  s_mov_b64 exec, 1
  v_mov_b32 v9, s51
  ds_write_b32 v10, v9 offset:0
  s_mov_b64 exec, -1
  s_waitcnt vmcnt(18)
  buffer_load_dwordx4 v7, s[40:43], s45 offen offset:3072 nt lds
  s_add_u32 s45, s45, 0x1000
  s_and_b32 m0, s45, 0x1ffff
  s_add_u32 s50, s50, 1
  s_and_b32 s47, s50, 3
  s_cbranch_scc1 L_ldb0
  s_branch L_ld_bot
L_ldb1:
  s_waitcnt vmcnt(19)
  buffer_load_dwordx4 v4, s[40:43], s45 offen offset:0 nt lds
  s_waitcnt vmcnt(19)
  buffer_load_dwordx4 v5, s[40:43], s45 offen offset:1024 nt lds
  ds_read_b32 v8, v11
  ds_read_b32 v12, v10 offset:20
  s_waitcnt vmcnt(19)
  buffer_load_dwordx4 v6, s[40:43], s45 offen offset:2048 nt lds
  s_waitcnt vmcnt(19)
  buffer_load_dwordx4 v7, s[40:43], s45 offen offset:3072 nt lds
  s_add_i32 s47, s50, -4
  s_max_i32 s51, s51, s47
  s_mov_b64 exec, 1
  v_mov_b32 v9, s51
  ds_write_b32 v10, v9 offset:0
  s_mov_b64 exec, -1
  s_add_u32 s45, s45, 0x1000
  s_and_b32 m0, s45, 0x1ffff
  s_add_u32 s50, s50, 1
  s_and_b32 s47, s50, 3
  s_cbranch_scc1 L_ldb1
  s_branch L_ld_bot
L_ldb3:
  s_waitcnt vmcnt(21)
  buffer_load_dwordx4 v4, s[40:43], s45 offen offset:0 nt lds
  s_waitcnt vmcnt(21)
  buffer_load_dwordx4 v5, s[40:43], s45 offen offset:1024 nt lds
  ds_read_b32 v8, v11
  ds_read_b32 v12, v10 offset:20
  s_add_i32 s47, s50, -5
  s_max_i32 s51, s51, s47
  s_mov_b64 exec, 1
  v_mov_b32 v9, s51
  ds_write_b32 v10, v9 offset:0
  s_mov_b64 exec, -1
  s_waitcnt vmcnt(21)
  buffer_load_dwordx4 v6, s[40:43], s45 offen offset:2048 nt lds
  s_waitcnt vmcnt(21)
  buffer_load_dwordx4 v7, s[40:43], s45 offen offset:3072 nt lds
  s_add_u32 s45, s45, 0x1000
  s_and_b32 m0, s45, 0x1ffff
  s_add_u32 s50, s50, 1
  s_and_b32 s47, s50, 3
  s_cbranch_scc1 L_ldb3
  s_branch L_ld_bot
L_ldb4:
  s_waitcnt vmcnt(22)
  buffer_load_dwordx4 v4, s[40:43], s45 offen offset:0 nt lds
  s_waitcnt vmcnt(22)
  buffer_load_dwordx4 v5, s[40:43], s45 offen offset:1024 nt lds
  ds_read_b32 v8, v11
  ds_read_b32 v12, v10 offset:20
  s_waitcnt vmcnt(22)
  buffer_load_dwordx4 v6, s[40:43], s45 offen offset:2048 nt lds
  s_add_i32 s47, s50, -5
  s_max_i32 s51, s51, s47
  s_mov_b64 exec, 1
  v_mov_b32 v9, s51
  ds_write_b32 v10, v9 offset:0
  s_mov_b64 exec, -1
  s_waitcnt vmcnt(22)
  buffer_load_dwordx4 v7, s[40:43], s45 offen offset:3072 nt lds
  s_add_u32 s45, s45, 0x1000
  s_and_b32 m0, s45, 0x1ffff
  s_add_u32 s50, s50, 1
  s_and_b32 s47, s50, 3
  s_cbranch_scc1 L_ldb4
  s_branch L_ld_bot
L_ldb5:
  s_waitcnt vmcnt(24)
  buffer_load_dwordx4 v4, s[40:43], s45 offen offset:0 nt lds
  s_add_i32 s47, s50, -6
  s_max_i32 s51, s51, s47
  s_mov_b64 exec, 1
  v_mov_b32 v9, s51
  ds_write_b32 v10, v9 offset:0
  s_mov_b64 exec, -1
  s_waitcnt vmcnt(24)
  buffer_load_dwordx4 v5, s[40:43], s45 offen offset:1024 nt lds
  ds_read_b32 v8, v11
  ds_read_b32 v12, v10 offset:20
  s_waitcnt vmcnt(24)
  buffer_load_dwordx4 v6, s[40:43], s45 offen offset:2048 nt lds
  s_waitcnt vmcnt(24)
  buffer_load_dwordx4 v7, s[40:43], s45 offen offset:3072 nt lds
  s_add_u32 s45, s45, 0x1000
  s_and_b32 m0, s45, 0x1ffff
  s_add_u32 s50, s50, 1
  s_and_b32 s47, s50, 3
  s_cbranch_scc1 L_ldb5
  s_branch L_ld_bot
L_ldb6:
  s_waitcnt vmcnt(26)
  buffer_load_dwordx4 v4, s[40:43], s45 offen offset:0 nt lds
  s_waitcnt vmcnt(26)
  buffer_load_dwordx4 v5, s[40:43], s45 offen offset:1024 nt lds
  ds_read_b32 v8, v11
  ds_read_b32 v12, v10 offset:20
  s_waitcnt vmcnt(26)
  buffer_load_dwordx4 v6, s[40:43], s45 offen offset:2048 nt lds
  s_add_i32 s47, s50, -6
  s_max_i32 s51, s51, s47
  s_mov_b64 exec, 1
  v_mov_b32 v9, s51
  ds_write_b32 v10, v9 offset:0
  s_mov_b64 exec, -1
  s_waitcnt vmcnt(26)
  buffer_load_dwordx4 v7, s[40:43], s45 offen offset:3072 nt lds
  s_add_u32 s45, s45, 0x1000
  s_and_b32 m0, s45, 0x1ffff
  s_add_u32 s50, s50, 1
  s_and_b32 s47, s50, 3
  s_cbranch_scc1 L_ldb6
  s_branch L_ld_bot
L_ld_drain:
  s_mov_b64 exec, 1
  s_waitcnt vmcnt(24)
  s_max_i32 s51, s51, 0x1fa
  v_mov_b32 v9, s51
  ds_write_b32 v10, v9 offset:0
  s_waitcnt vmcnt(20)
  s_max_i32 s51, s51, 0x1fb
  v_mov_b32 v9, s51
  ds_write_b32 v10, v9 offset:0
  s_waitcnt vmcnt(16)
  s_max_i32 s51, s51, 0x1fc
  v_mov_b32 v9, s51
  ds_write_b32 v10, v9 offset:0
  s_waitcnt vmcnt(12)
  s_max_i32 s51, s51, 0x1fd
  v_mov_b32 v9, s51
  ds_write_b32 v10, v9 offset:0
  s_waitcnt vmcnt(8)
  s_max_i32 s51, s51, 0x1fe
  v_mov_b32 v9, s51
  ds_write_b32 v10, v9 offset:0
  s_waitcnt vmcnt(4)
  s_max_i32 s51, s51, 0x1ff
  v_mov_b32 v9, s51
  ds_write_b32 v10, v9 offset:0
  s_waitcnt vmcnt(0)
  s_max_i32 s51, s51, 0x200
  v_mov_b32 v9, s51
  ds_write_b32 v10, v9 offset:0
  s_waitcnt lgkmcnt(0)
  s_endpgm
L_ln:
  v_mov_b32 v162, 1
  v_mov_b32 v12, 151808
  v_lshlrev_b32 v37, 2, v1
  s_mul_i32 s55, s36, 1280
  s_mov_b32 s42, 10240
  s_mov_b32 s43, 0x20000
  s_waitcnt lgkmcnt(0)
  s_mov_b32 s40, s8
  s_mov_b32 s41, s9
  buffer_load_dword v39, v37, s[40:43], s55 offen offset:0
  buffer_load_dword v40, v37, s[40:43], s55 offen offset:256
  buffer_load_dword v41, v37, s[40:43], s55 offen offset:512
  buffer_load_dword v42, v37, s[40:43], s55 offen offset:768
  buffer_load_dword v43, v37, s[40:43], s55 offen offset:1024
  s_lshl_b32 s57, s36, 5
  v_mov_b32 v30, s57
  s_cmp_lg_u32 s37, 0
  s_cbranch_scc1 L_nononce
  s_memrealtime s[62:63]
  s_waitcnt lgkmcnt(0)
  s_or_b32 s62, s62, 1
  v_mov_b32 v28, s62
  s_mov_b64 exec, 1
  global_store_dword v30, v28, s[30:31] sc1
  s_mov_b64 exec, -1
L_nononce:
  v_lshlrev_b32 v37, 3, v1
  v_add_u32 v38, 154112, v37
  v_add_u32 v37, 131072, v37
  s_waitcnt vmcnt(0)
  v_lshlrev_b32 v45, 16, v39
  v_and_b32 v46, 0xffff0000, v39
  v_lshlrev_b32 v47, 16, v40
  v_and_b32 v48, 0xffff0000, v40
  v_lshlrev_b32 v49, 16, v41
  v_and_b32 v50, 0xffff0000, v41
  v_lshlrev_b32 v51, 16, v42
  v_and_b32 v52, 0xffff0000, v42
  v_lshlrev_b32 v53, 16, v43
  v_and_b32 v54, 0xffff0000, v43
  v_add_f32 v33, v45, v46
  v_add_f32 v33, v33, v47
  v_add_f32 v33, v33, v48
  v_add_f32 v33, v33, v49
  v_add_f32 v33, v33, v50
  v_add_f32 v33, v33, v51
  v_add_f32 v33, v33, v52
  v_add_f32 v33, v33, v53
  v_add_f32 v33, v33, v54
  s_nop 1
  v_add_f32_dpp v33, v33, v33 quad_perm:[1,0,3,2] row_mask:0xf bank_mask:0xf
  s_nop 1
  v_add_f32_dpp v33, v33, v33 quad_perm:[2,3,0,1] row_mask:0xf bank_mask:0xf
  s_nop 1
  v_add_f32_dpp v33, v33, v33 row_half_mirror row_mask:0xf bank_mask:0xf
  s_nop 1
  v_add_f32_dpp v33, v33, v33 row_mirror row_mask:0xf bank_mask:0xf
  s_nop 1
  v_add_f32_dpp v33, v33, v33 row_bcast:15 row_mask:0xa bank_mask:0xf
  s_nop 1
  v_add_f32_dpp v33, v33, v33 row_bcast:31 row_mask:0xc bank_mask:0xf
  s_nop 0
  v_readlane_b32 s51, v33, 63
  v_mov_b32 v34, 0x3acccccd
  s_nop 0
  v_mul_f32 v34, s51, v34
  v_sub_f32 v160, v45, v34
  v_mul_f32 v33, v160, v160
  v_sub_f32 v160, v46, v34
  v_fmac_f32 v33, v160, v160
  v_sub_f32 v160, v47, v34
  v_fmac_f32 v33, v160, v160
  v_sub_f32 v160, v48, v34
  v_fmac_f32 v33, v160, v160
  v_sub_f32 v160, v49, v34
  v_fmac_f32 v33, v160, v160
  v_sub_f32 v160, v50, v34
  v_fmac_f32 v33, v160, v160
  v_sub_f32 v160, v51, v34
  v_fmac_f32 v33, v160, v160
  v_sub_f32 v160, v52, v34
  v_fmac_f32 v33, v160, v160
  v_sub_f32 v160, v53, v34
  v_fmac_f32 v33, v160, v160
  v_sub_f32 v160, v54, v34
  v_fmac_f32 v33, v160, v160
  s_nop 1
  v_add_f32_dpp v33, v33, v33 quad_perm:[1,0,3,2] row_mask:0xf bank_mask:0xf
  s_nop 1
  v_add_f32_dpp v33, v33, v33 quad_perm:[2,3,0,1] row_mask:0xf bank_mask:0xf
  s_nop 1
  v_add_f32_dpp v33, v33, v33 row_half_mirror row_mask:0xf bank_mask:0xf
  s_nop 1
  v_add_f32_dpp v33, v33, v33 row_mirror row_mask:0xf bank_mask:0xf
  s_nop 1
  v_add_f32_dpp v33, v33, v33 row_bcast:15 row_mask:0xa bank_mask:0xf
  s_nop 1
  v_add_f32_dpp v33, v33, v33 row_bcast:31 row_mask:0xc bank_mask:0xf
  s_nop 0
  v_readlane_b32 s51, v33, 63
  v_cvt_pk_bf16_f32 v34, v34, v34
  v_and_b32 v34, 0xffff0000, v34
  s_nop 0
  v_readfirstlane_b32 s58, v34
  v_mov_b32 v33, 0x3acccccd
  v_mul_f32 v33, s51, v33
  v_cvt_pk_bf16_f32 v33, v33, v33
  v_and_b32 v33, 0xffff0000, v33
  v_add_f32 v33, 0x3727c5ac, v33
  v_cvt_pk_bf16_f32 v33, v33, v33
  v_and_b32 v33, 0xffff0000, v33
  v_sqrt_f32 v33, v33
  s_nop 0
  v_cvt_pk_bf16_f32 v33, v33, v33
  v_and_b32 v33, 0xffff0000, v33
  s_nop 0
  v_readfirstlane_b32 s59, v33
  s_nop 1
  v_mov_b32 v33, s59
  v_rcp_f32 v34, v33
  v_subrev_f32 v160, s58, v45
  v_cvt_pk_bf16_f32 v160, v160, v160
  v_and_b32 v160, 0xffff0000, v160
  v_mul_f32 v161, v160, v34
  v_fma_f32 v160, -v161, v33, v160
  v_fmac_f32 v161, v160, v34
  v_cvt_pk_bf16_f32 v56, v161, v161
  v_and_b32 v56, 0xffff0000, v56
  v_subrev_f32 v160, s58, v46
  v_cvt_pk_bf16_f32 v160, v160, v160
  v_and_b32 v160, 0xffff0000, v160
  v_mul_f32 v161, v160, v34
  v_fma_f32 v160, -v161, v33, v160
  v_fmac_f32 v161, v160, v34
  v_cvt_pk_bf16_f32 v57, v161, v161
  v_and_b32 v57, 0xffff0000, v57
  v_subrev_f32 v160, s58, v47
  v_cvt_pk_bf16_f32 v160, v160, v160
  v_and_b32 v160, 0xffff0000, v160
  v_mul_f32 v161, v160, v34
  v_fma_f32 v160, -v161, v33, v160
  v_fmac_f32 v161, v160, v34
  v_cvt_pk_bf16_f32 v58, v161, v161
  v_and_b32 v58, 0xffff0000, v58
  v_subrev_f32 v160, s58, v48
  v_cvt_pk_bf16_f32 v160, v160, v160
  v_and_b32 v160, 0xffff0000, v160
  v_mul_f32 v161, v160, v34
  v_fma_f32 v160, -v161, v33, v160
  v_fmac_f32 v161, v160, v34
  v_cvt_pk_bf16_f32 v59, v161, v161
  v_and_b32 v59, 0xffff0000, v59
  v_subrev_f32 v160, s58, v49
  v_cvt_pk_bf16_f32 v160, v160, v160
  v_and_b32 v160, 0xffff0000, v160
  v_mul_f32 v161, v160, v34
  v_fma_f32 v160, -v161, v33, v160
  v_fmac_f32 v161, v160, v34
  v_cvt_pk_bf16_f32 v60, v161, v161
  v_and_b32 v60, 0xffff0000, v60
  v_subrev_f32 v160, s58, v50
  v_cvt_pk_bf16_f32 v160, v160, v160
  v_and_b32 v160, 0xffff0000, v160
  v_mul_f32 v161, v160, v34
  v_fma_f32 v160, -v161, v33, v160
  v_fmac_f32 v161, v160, v34
  v_cvt_pk_bf16_f32 v61, v161, v161
  v_and_b32 v61, 0xffff0000, v61
  v_subrev_f32 v160, s58, v51
  v_cvt_pk_bf16_f32 v160, v160, v160
  v_and_b32 v160, 0xffff0000, v160
  v_mul_f32 v161, v160, v34
  v_fma_f32 v160, -v161, v33, v160
  v_fmac_f32 v161, v160, v34
  v_cvt_pk_bf16_f32 v62, v161, v161
  v_and_b32 v62, 0xffff0000, v62
  v_subrev_f32 v160, s58, v52
  v_cvt_pk_bf16_f32 v160, v160, v160
  v_and_b32 v160, 0xffff0000, v160
  v_mul_f32 v161, v160, v34
  v_fma_f32 v160, -v161, v33, v160
  v_fmac_f32 v161, v160, v34
  v_cvt_pk_bf16_f32 v63, v161, v161
  v_and_b32 v63, 0xffff0000, v63
  v_subrev_f32 v160, s58, v53
  v_cvt_pk_bf16_f32 v160, v160, v160
  v_and_b32 v160, 0xffff0000, v160
  v_mul_f32 v161, v160, v34
  v_fma_f32 v160, -v161, v33, v160
  v_fmac_f32 v161, v160, v34
  v_cvt_pk_bf16_f32 v64, v161, v161
  v_and_b32 v64, 0xffff0000, v64
  v_subrev_f32 v160, s58, v54
  v_cvt_pk_bf16_f32 v160, v160, v160
  v_and_b32 v160, 0xffff0000, v160
  v_mul_f32 v161, v160, v34
  v_fma_f32 v160, -v161, v33, v160
  v_fmac_f32 v161, v160, v34
  v_cvt_pk_bf16_f32 v65, v161, v161
  v_and_b32 v65, 0xffff0000, v65
  v_cvt_pk_bf16_f32 v40, v56, v56
  v_cvt_pk_bf16_f32 v41, v57, v57
  ds_write_b64 v37, v[40:41] offset:0
  ds_write_b64 v37, v[40:41] offset:2560
  v_cvt_pk_bf16_f32 v40, v58, v58
  v_cvt_pk_bf16_f32 v41, v59, v59
  ds_write_b64 v37, v[40:41] offset:512
  ds_write_b64 v37, v[40:41] offset:3072
  v_cvt_pk_bf16_f32 v40, v60, v60
  v_cvt_pk_bf16_f32 v41, v61, v61
  ds_write_b64 v37, v[40:41] offset:1024
  ds_write_b64 v37, v[40:41] offset:3584
  v_cvt_pk_bf16_f32 v40, v62, v62
  v_cvt_pk_bf16_f32 v41, v63, v63
  ds_write_b64 v37, v[40:41] offset:1536
  ds_write_b64 v37, v[40:41] offset:4096
  v_cvt_pk_bf16_f32 v40, v64, v64
  v_cvt_pk_bf16_f32 v41, v65, v65
  ds_write_b64 v37, v[40:41] offset:2048
  ds_write_b64 v37, v[40:41] offset:4608
  s_waitcnt lgkmcnt(0)
  s_mov_b64 exec, 1
  ds_write_b32 v12, v162 offset:16
  s_mov_b64 exec, -1
  v_add_f32 v33, v56, v57
  v_add_f32 v33, v33, v58
  v_add_f32 v33, v33, v59
  v_add_f32 v33, v33, v60
  v_add_f32 v33, v33, v61
  v_add_f32 v33, v33, v62
  v_add_f32 v33, v33, v63
  v_add_f32 v33, v33, v64
  v_add_f32 v33, v33, v65
  s_nop 1
  v_add_f32_dpp v33, v33, v33 quad_perm:[1,0,3,2] row_mask:0xf bank_mask:0xf
  s_nop 1
  v_add_f32_dpp v33, v33, v33 quad_perm:[2,3,0,1] row_mask:0xf bank_mask:0xf
  s_nop 1
  v_add_f32_dpp v33, v33, v33 row_half_mirror row_mask:0xf bank_mask:0xf
  s_nop 1
  v_add_f32_dpp v33, v33, v33 row_mirror row_mask:0xf bank_mask:0xf
  s_nop 1
  v_add_f32_dpp v33, v33, v33 row_bcast:15 row_mask:0xa bank_mask:0xf
  s_nop 1
  v_add_f32_dpp v33, v33, v33 row_bcast:31 row_mask:0xc bank_mask:0xf
  s_nop 0
  v_readlane_b32 s51, v33, 63
  v_mov_b32 v34, 0x3acccccd
  s_nop 0
  v_mul_f32 v34, s51, v34
  v_sub_f32 v160, v56, v34
  v_mul_f32 v33, v160, v160
  v_sub_f32 v160, v57, v34
  v_fmac_f32 v33, v160, v160
  v_sub_f32 v160, v58, v34
  v_fmac_f32 v33, v160, v160
  v_sub_f32 v160, v59, v34
  v_fmac_f32 v33, v160, v160
  v_sub_f32 v160, v60, v34
  v_fmac_f32 v33, v160, v160
  v_sub_f32 v160, v61, v34
  v_fmac_f32 v33, v160, v160
  v_sub_f32 v160, v62, v34
  v_fmac_f32 v33, v160, v160
  v_sub_f32 v160, v63, v34
  v_fmac_f32 v33, v160, v160
  v_sub_f32 v160, v64, v34
  v_fmac_f32 v33, v160, v160
  v_sub_f32 v160, v65, v34
  v_fmac_f32 v33, v160, v160
  s_nop 1
  v_add_f32_dpp v33, v33, v33 quad_perm:[1,0,3,2] row_mask:0xf bank_mask:0xf
  s_nop 1
  v_add_f32_dpp v33, v33, v33 quad_perm:[2,3,0,1] row_mask:0xf bank_mask:0xf
  s_nop 1
  v_add_f32_dpp v33, v33, v33 row_half_mirror row_mask:0xf bank_mask:0xf
  s_nop 1
  v_add_f32_dpp v33, v33, v33 row_mirror row_mask:0xf bank_mask:0xf
  s_nop 1
  v_add_f32_dpp v33, v33, v33 row_bcast:15 row_mask:0xa bank_mask:0xf
  s_nop 1
  v_add_f32_dpp v33, v33, v33 row_bcast:31 row_mask:0xc bank_mask:0xf
  s_nop 0
  v_readlane_b32 s51, v33, 63
  v_cvt_pk_bf16_f32 v34, v34, v34
  v_and_b32 v34, 0xffff0000, v34
  s_nop 0
  v_readfirstlane_b32 s58, v34
  v_mov_b32 v33, 0x3acccccd
  v_mul_f32 v33, s51, v33
  v_cvt_pk_bf16_f32 v33, v33, v33
  v_and_b32 v33, 0xffff0000, v33
  v_add_f32 v33, 0x3727c5ac, v33
  v_cvt_pk_bf16_f32 v33, v33, v33
  v_and_b32 v33, 0xffff0000, v33
  v_sqrt_f32 v33, v33
  s_nop 0
  v_cvt_pk_bf16_f32 v33, v33, v33
  v_and_b32 v33, 0xffff0000, v33
  s_nop 0
  v_readfirstlane_b32 s59, v33
  s_nop 1
  v_mov_b32 v33, s59
  v_rcp_f32 v34, v33
  v_subrev_f32 v160, s58, v56
  v_cvt_pk_bf16_f32 v160, v160, v160
  v_and_b32 v160, 0xffff0000, v160
  v_mul_f32 v161, v160, v34
  v_fma_f32 v160, -v161, v33, v160
  v_fmac_f32 v161, v160, v34
  v_cvt_pk_bf16_f32 v56, v161, v161
  v_and_b32 v56, 0xffff0000, v56
  v_subrev_f32 v160, s58, v57
  v_cvt_pk_bf16_f32 v160, v160, v160
  v_and_b32 v160, 0xffff0000, v160
  v_mul_f32 v161, v160, v34
  v_fma_f32 v160, -v161, v33, v160
  v_fmac_f32 v161, v160, v34
  v_cvt_pk_bf16_f32 v57, v161, v161
  v_and_b32 v57, 0xffff0000, v57
  v_subrev_f32 v160, s58, v58
  v_cvt_pk_bf16_f32 v160, v160, v160
  v_and_b32 v160, 0xffff0000, v160
  v_mul_f32 v161, v160, v34
  v_fma_f32 v160, -v161, v33, v160
  v_fmac_f32 v161, v160, v34
  v_cvt_pk_bf16_f32 v58, v161, v161
  v_and_b32 v58, 0xffff0000, v58
  v_subrev_f32 v160, s58, v59
  v_cvt_pk_bf16_f32 v160, v160, v160
  v_and_b32 v160, 0xffff0000, v160
  v_mul_f32 v161, v160, v34
  v_fma_f32 v160, -v161, v33, v160
  v_fmac_f32 v161, v160, v34
  v_cvt_pk_bf16_f32 v59, v161, v161
  v_and_b32 v59, 0xffff0000, v59
  v_subrev_f32 v160, s58, v60
  v_cvt_pk_bf16_f32 v160, v160, v160
  v_and_b32 v160, 0xffff0000, v160
  v_mul_f32 v161, v160, v34
  v_fma_f32 v160, -v161, v33, v160
  v_fmac_f32 v161, v160, v34
  v_cvt_pk_bf16_f32 v60, v161, v161
  v_and_b32 v60, 0xffff0000, v60
  v_subrev_f32 v160, s58, v61
  v_cvt_pk_bf16_f32 v160, v160, v160
  v_and_b32 v160, 0xffff0000, v160
  v_mul_f32 v161, v160, v34
  v_fma_f32 v160, -v161, v33, v160
  v_fmac_f32 v161, v160, v34
  v_cvt_pk_bf16_f32 v61, v161, v161
  v_and_b32 v61, 0xffff0000, v61
  v_subrev_f32 v160, s58, v62
  v_cvt_pk_bf16_f32 v160, v160, v160
  v_and_b32 v160, 0xffff0000, v160
  v_mul_f32 v161, v160, v34
  v_fma_f32 v160, -v161, v33, v160
  v_fmac_f32 v161, v160, v34
  v_cvt_pk_bf16_f32 v62, v161, v161
  v_and_b32 v62, 0xffff0000, v62
  v_subrev_f32 v160, s58, v63
  v_cvt_pk_bf16_f32 v160, v160, v160
  v_and_b32 v160, 0xffff0000, v160
  v_mul_f32 v161, v160, v34
  v_fma_f32 v160, -v161, v33, v160
  v_fmac_f32 v161, v160, v34
  v_cvt_pk_bf16_f32 v63, v161, v161
  v_and_b32 v63, 0xffff0000, v63
  v_subrev_f32 v160, s58, v64
  v_cvt_pk_bf16_f32 v160, v160, v160
  v_and_b32 v160, 0xffff0000, v160
  v_mul_f32 v161, v160, v34
  v_fma_f32 v160, -v161, v33, v160
  v_fmac_f32 v161, v160, v34
  v_cvt_pk_bf16_f32 v64, v161, v161
  v_and_b32 v64, 0xffff0000, v64
  v_subrev_f32 v160, s58, v65
  v_cvt_pk_bf16_f32 v160, v160, v160
  v_and_b32 v160, 0xffff0000, v160
  v_mul_f32 v161, v160, v34
  v_fma_f32 v160, -v161, v33, v160
  v_fmac_f32 v161, v160, v34
  v_cvt_pk_bf16_f32 v65, v161, v161
  v_and_b32 v65, 0xffff0000, v65
  ds_write_b64 v38, v[56:57] offset:0
  ds_write_b64 v38, v[58:59] offset:512
  ds_write_b64 v38, v[60:61] offset:1024
  ds_write_b64 v38, v[62:63] offset:1536
  ds_write_b64 v38, v[64:65] offset:2048
  s_waitcnt lgkmcnt(0)
  s_mov_b64 exec, 1
  ds_add_u32 v12, v162 offset:4
  s_mov_b64 exec, -1
  s_mov_b32 s52, 44
  s_mov_b32 s53, 0
  s_mov_b32 s54, 0
  s_mov_b32 s80, 0
  s_and_b32 s57, s2, 7
  v_cmp_eq_u32 s[68:69], s57, v1
  s_mul_i32 s57, s57, 33
  v_lshlrev_b32 v24, 2, v1
  v_add_u32 v24, 1310720, v24
  v_mov_b32 v26, 4000
L_ctl:
L_wf_7:
  ds_read_b32 v15, v12 offset:0
  s_waitcnt lgkmcnt(0)
  v_readfirstlane_b32 s50, v15
  s_nop 0
  s_cmp_ge_u32 s50, s52
  s_cbranch_scc1 L_wfd_8
  s_sleep 1
  s_branch L_wf_7
L_wfd_8:
  s_memrealtime s[58:59]
  s_add_u32 s52, s52, 16
  s_cmp_lg_u32 s57, s2
  s_waitcnt lgkmcnt(0)
  s_cbranch_scc1 L_ctl_nw
  v_mov_b32 v21, s58
  s_mov_b64 exec, s[68:69]
  global_store_dword v24, v21, s[32:33] sc1
  s_mov_b64 exec, -1
L_ctl_nw:
L_wf_9:
  ds_read_b32 v15, v12 offset:0
  s_waitcnt lgkmcnt(0)
  v_readfirstlane_b32 s50, v15
  s_nop 0
  s_cmp_ge_u32 s50, s52
  s_cbranch_scc1 L_wfd_10
  s_sleep 2
  s_branch L_wf_9
L_wfd_10:
  s_mov_b64 exec, 0xff
  global_load_dword v22, v24, s[32:33] sc1
  s_memrealtime s[60:61]
  s_waitcnt lgkmcnt(0)
  s_sub_u32 s60, s60, s58
  v_mov_b32 v25, s60
  s_waitcnt vmcnt(0)
  v_subrev_u32 v22, s58, v22
  v_add_u32 v21, 2000, v22
  v_cmp_gt_u32 vcc, v26, v21
  s_nop 1
  v_cndmask_b32 v22, v25, v22, vcc
  s_nop 1
  v_add_u32_dpp v22, v22, v22 quad_perm:[1,0,3,2] row_mask:0xf bank_mask:0xf
  s_nop 1
  v_add_u32_dpp v22, v22, v22 quad_perm:[2,3,0,1] row_mask:0xf bank_mask:0xf
  s_nop 1
  v_add_u32_dpp v22, v22, v22 row_half_mirror row_mask:0xf bank_mask:0xf
  s_lshl_b32 s78, s58, 3
  v_readfirstlane_b32 s58, v22
  s_nop 0
  s_add_i32 s58, s58, 64
  s_ashr_i32 s58, s58, 7
  s_sub_i32 s58, 2, s58
  s_max_i32 s58, s58, 0
  s_min_i32 s58, s58, 6
  s_xor_b32 s58, s58, 2
  v_mov_b32 v21, s58
  s_mov_b64 exec, 1
  ds_write_b32 v12, v21 offset:20
  s_mov_b64 exec, -1
  v_add_u32 v24, 4352, v24
  s_add_u32 s52, s52, 16
  s_add_u32 s53, s53, 1
  s_cmp_eq_u32 s53, 11
  s_cbranch_scc1 L_gate
L_gate_ret:
  s_cmp_lt_u32 s53, 14
  s_cbranch_scc1 L_ctl
  s_waitcnt lgkmcnt(0)
  s_endpgm
L_gate:
  s_mul_i32 s60, s37, 40
  v_lshl_add_u32 v43, v1, 2, s60
  v_lshlrev_b32 v40, 3, v1
  v_add_u32 v41, 152064, v40
  s_load_dword s64, s[26:27], 0
  s_mov_b64 exec, 0x3ff
  buffer_load_dword v50, v43, s[40:43], s55 offen
  ds_read_b64 v[52:53], v41 offset:0
  ds_read_b64 v[54:55], v41 offset:256
  ds_read_b64 v[56:57], v41 offset:512
  ds_read_b64 v[58:59], v41 offset:768
  ds_read_b64 v[60:61], v41 offset:1024
  ds_read_b64 v[62:63], v41 offset:1280
  ds_read_b64 v[64:65], v41 offset:1536
  ds_read_b64 v[66:67], v41 offset:1792
  s_waitcnt vmcnt(0) lgkmcnt(0)
  v_add_f32 v44, v52, v54
  v_add_f32 v45, v53, v55
  v_add_f32 v44, v44, v56
  v_add_f32 v45, v45, v57
  v_add_f32 v44, v44, v58
  v_add_f32 v45, v45, v59
  v_add_f32 v44, v44, v60
  v_add_f32 v45, v45, v61
  v_add_f32 v44, v44, v62
  v_add_f32 v45, v45, v63
  v_add_f32 v44, v44, v64
  v_add_f32 v45, v45, v65
  v_add_f32 v44, v44, v66
  v_add_f32 v45, v45, v67
  s_waitcnt lgkmcnt(0)
  s_lshl_b32 s64, s64, 16
  s_mov_b32 s65, 0xbfb8aa3b
  v_cvt_pk_bf16_f32 v44, v44, v45
  v_and_b32 v45, 0xffff0000, v44
  v_lshlrev_b32 v44, 16, v44
  v_add_f32 v44, s64, v44
  v_add_f32 v45, s64, v45
  v_cvt_pk_bf16_f32 v44, v44, v45
  v_and_b32 v45, 0xffff0000, v44
  v_lshlrev_b32 v44, 16, v44
  v_mul_f32 v46, s65, v44
  v_mul_f32 v47, s65, v45
  v_exp_f32 v46, v46
  v_exp_f32 v47, v47
  v_add_f32 v46, 1.0, v46
  v_add_f32 v47, 1.0, v47
  v_rcp_f32 v46, v46
  v_rcp_f32 v47, v47
  v_mul_f32 v44, v44, v46
  v_mul_f32 v45, v45, v47
  v_cvt_pk_bf16_f32 v44, v44, v45
  v_and_b32 v45, 0xffff0000, v44
  v_lshlrev_b32 v44, 16, v44
  v_and_b32 v47, 0xffff0000, v50
  v_lshlrev_b32 v46, 16, v50
  v_add_u32 v40, 151552, v40
  ds_write_b64 v40, v[44:45]
  ds_write_b64 v40, v[46:47] offset:128
  s_mov_b64 exec, 1
  s_mov_b32 s65, 0
L_npoll:
  global_load_dword v31, v30, s[30:31] sc1
  s_waitcnt vmcnt(0)
  v_readfirstlane_b32 s62, v31
  s_add_u32 s65, s65, 1
  s_cmp_ge_u32 s65, 0x20000
  s_cbranch_scc1 L_ndone
  s_cmp_eq_u32 s62, 0
  s_cbranch_scc1 L_npoll
L_ndone:
  ds_write_b32 v12, v31 offset:12
  s_mov_b64 exec, -1
  s_branch L_gate_ret
L_worker2:
  v_lshlrev_b32 v36, 13, v2
  v_lshl_add_u32 v36, v3, 4, v36
  s_lshl_b32 s57, s37, 8
  v_add_u32 v36, s57, v36
  s_mul_i32 s60, s36, 20
  s_add_u32 s60, s60, s35
  s_lshl_b32 s56, s60, 15
  s_mov_b32 s46, 5242880
  s_mov_b32 s47, 0x20000
  s_waitcnt lgkmcnt(0)
  s_mov_b32 s44, s14
  s_mov_b32 s45, s15
  buffer_load_dwordx4 v[128:131], v36, s[44:47], s56 offen
  s_add_u32 s56, s56, 0x40000
  s_sub_u32 s57, s56, 0x500000
  s_min_u32 s56, s56, s57
  buffer_load_dwordx4 v[132:135], v36, s[44:47], s56 offen
  s_add_u32 s56, s56, 0x40000
  s_sub_u32 s57, s56, 0x500000
  s_min_u32 s56, s56, s57
  buffer_load_dwordx4 v[136:139], v36, s[44:47], s56 offen
  s_add_u32 s56, s56, 0x40000
  s_sub_u32 s57, s56, 0x500000
  s_min_u32 s56, s56, s57
  buffer_load_dwordx4 v[140:143], v36, s[44:47], s56 offen
  s_add_u32 s56, s56, 0x40000
  s_sub_u32 s57, s56, 0x500000
  s_min_u32 s56, s56, s57
  v_mov_b32 v162, 1
  v_mov_b32 v12, 151808
  s_mov_b32 s43, 0x20000
  s_lshl_b32 s57, s35, 2
  s_add_u32 s48, s57, 4
  s_add_u32 s57, s57, 151872
  v_mov_b32 v13, s57
  v_lshrrev_b32 v38, 1, v3
  v_and_b32 v39, 1, v3
  v_mov_b32 v160, 0xffff
  v_mov_b32 v161, 0xffff0000
  v_cmp_eq_u32 vcc, 1, v39
  s_nop 1
  v_cndmask_b32 v160, v160, v161, vcc
  v_cmp_eq_u32 vcc, 0, v38
  s_nop 1
  v_cndmask_b32 v4, 0, v160, vcc
  v_cmp_eq_u32 vcc, 1, v38
  s_nop 1
  v_cndmask_b32 v5, 0, v160, vcc
  v_cmp_eq_u32 vcc, 2, v38
  s_nop 1
  v_cndmask_b32 v6, 0, v160, vcc
  v_cmp_eq_u32 vcc, 3, v38
  s_nop 1
  v_cndmask_b32 v7, 0, v160, vcc
  v_cmp_eq_u32 s[66:67], 1, v2
  v_cmp_eq_u32 s[68:69], 2, v2
  v_cmp_eq_u32 s[70:71], 3, v2
  s_lshl_b32 s57, s35, 14
  v_xor_b32 v38, v2, v3
  v_lshlrev_b32 v38, 4, v38
  v_lshl_add_u32 v38, v3, 8, v38
  v_add_u32 v8, s57, v38
  v_xor_b32 v9, 64, v8
  v_xor_b32 v10, 0x80, v8
  v_xor_b32 v11, 0xc0, v8
  s_lshl_b32 s57, s60, 4
  s_add_u32 s57, s57, 131072
  v_lshl_add_u32 v37, v2, 2, s57
  s_mov_b32 s61, 0
  s_waitcnt vmcnt(1)
  buffer_load_dwordx4 v[40:43], v36, s[44:47], s56 offen
  s_add_u32 s56, s56, 0x40000
  s_sub_u32 s57, s56, 0x500000
  s_min_u32 s56, s56, s57
  s_cmp_lg_u32 s61, 0
  s_cbranch_scc1 L_dr_11
  ds_read_b32 v15, v12 offset:0
  s_waitcnt lgkmcnt(0)
  v_readfirstlane_b32 s50, v15
  s_nop 0
  s_cmp_ge_u32 s50, s48
  s_cbranch_scc0 L_dr_11
  ds_read_b128 v[64:67], v8 offset:0
  ds_read_b128 v[68:71], v9 offset:0
  ds_read_b128 v[72:75], v10 offset:0
  ds_read_b128 v[76:79], v11 offset:0
  ds_read_b128 v[80:83], v8 offset:4096
  ds_read_b128 v[84:87], v9 offset:4096
  ds_read_b128 v[88:91], v10 offset:4096
  ds_read_b128 v[92:95], v11 offset:4096
  ds_read_b128 v[96:99], v8 offset:8192
  ds_read_b128 v[100:103], v9 offset:8192
  ds_read_b128 v[104:107], v10 offset:8192
  ds_read_b128 v[108:111], v11 offset:8192
  ds_read_b128 v[112:115], v8 offset:12288
  ds_read_b128 v[116:119], v9 offset:12288
  ds_read_b128 v[120:123], v10 offset:12288
  ds_read_b128 v[124:127], v11 offset:12288
  s_mov_b32 s61, 1
  s_waitcnt lgkmcnt(0)
  s_mov_b64 exec, 1
  ds_write_b32 v13, v162
  s_mov_b64 exec, -1
L_dr_11:
  s_waitcnt vmcnt(1)
  buffer_load_dwordx4 v[44:47], v36, s[44:47], s56 offen
  s_add_u32 s56, s56, 0x40000
  s_sub_u32 s57, s56, 0x500000
  s_min_u32 s56, s56, s57
  s_waitcnt vmcnt(1)
  buffer_load_dwordx4 v[48:51], v36, s[44:47], s56 offen
  s_add_u32 s56, s56, 0x40000
  s_sub_u32 s57, s56, 0x500000
  s_min_u32 s56, s56, s57
  s_waitcnt vmcnt(1)
  buffer_load_dwordx4 v[52:55], v36, s[44:47], s56 offen
  s_add_u32 s56, s56, 0x40000
  s_sub_u32 s57, s56, 0x500000
  s_min_u32 s56, s56, s57
  s_cmp_lg_u32 s61, 0
  s_cbranch_scc1 L_dr_12
  ds_read_b32 v15, v12 offset:0
  s_waitcnt lgkmcnt(0)
  v_readfirstlane_b32 s50, v15
  s_nop 0
  s_cmp_ge_u32 s50, s48
  s_cbranch_scc0 L_dr_12
  ds_read_b128 v[64:67], v8 offset:0
  ds_read_b128 v[68:71], v9 offset:0
  ds_read_b128 v[72:75], v10 offset:0
  ds_read_b128 v[76:79], v11 offset:0
  ds_read_b128 v[80:83], v8 offset:4096
  ds_read_b128 v[84:87], v9 offset:4096
  ds_read_b128 v[88:91], v10 offset:4096
  ds_read_b128 v[92:95], v11 offset:4096
  ds_read_b128 v[96:99], v8 offset:8192
  ds_read_b128 v[100:103], v9 offset:8192
  ds_read_b128 v[104:107], v10 offset:8192
  ds_read_b128 v[108:111], v11 offset:8192
  ds_read_b128 v[112:115], v8 offset:12288
  ds_read_b128 v[116:119], v9 offset:12288
  ds_read_b128 v[120:123], v10 offset:12288
  ds_read_b128 v[124:127], v11 offset:12288
  s_mov_b32 s61, 1
  s_waitcnt lgkmcnt(0)
  s_mov_b64 exec, 1
  ds_write_b32 v13, v162
  s_mov_b64 exec, -1
L_dr_12:
L_wx:
  ds_read_b32 v15, v12 offset:16
  s_waitcnt lgkmcnt(0)
  v_readfirstlane_b32 s50, v15
  s_nop 0
  s_cmp_eq_u32 s50, 0
  s_cbranch_scc1 L_wx
  ds_read2_b32 v[16:17], v37 offset0:0 offset1:32
  ds_read2_b32 v[18:19], v37 offset0:64 offset1:96
  ds_read2_b32 v[20:21], v37 offset0:128 offset1:160
  ds_read2_b32 v[22:23], v37 offset0:192 offset1:224
  ds_read_b32 v24, v37 offset:1024
  ds_read_b32 v25, v37 offset:1152
  ds_read_b32 v26, v37 offset:1280
  ds_read_b32 v27, v37 offset:1408
  ds_read_b32 v28, v37 offset:1536
  ds_read_b32 v29, v37 offset:1664
  ds_read_b32 v30, v37 offset:1792
  ds_read_b32 v31, v37 offset:1920
  ds_read_b32 v32, v37 offset:2048
  ds_read_b32 v33, v37 offset:2176
  ds_read_b32 v34, v37 offset:2304
  ds_read_b32 v35, v37 offset:2432
  s_waitcnt lgkmcnt(0)
  v_and_b32 v144, v16, v4
  v_and_b32 v145, v16, v5
  v_and_b32 v146, v16, v6
  v_and_b32 v147, v16, v7
  s_waitcnt vmcnt(7)
  s_nop 0
  v_mfma_f32_16x16x32_bf16 v[152:155], v[144:147], v[128:131], 0
  s_waitcnt vmcnt(1)
  buffer_load_dwordx4 v[56:59], v36, s[44:47], s56 offen
  s_add_u32 s56, s56, 0x40000
  s_sub_u32 s57, s56, 0x500000
  s_min_u32 s56, s56, s57
  v_and_b32 v148, v17, v4
  v_and_b32 v149, v17, v5
  v_and_b32 v150, v17, v6
  v_and_b32 v151, v17, v7
  s_waitcnt vmcnt(7)
  s_nop 0
  v_mfma_f32_16x16x32_bf16 v[152:155], v[148:151], v[132:135], v[152:155]
  s_waitcnt vmcnt(1)
  buffer_load_dwordx4 v[60:63], v36, s[44:47], s56 offen
  s_add_u32 s56, s56, 0x40000
  s_sub_u32 s57, s56, 0x500000
  s_min_u32 s56, s56, s57
  v_and_b32 v144, v18, v4
  v_and_b32 v145, v18, v5
  v_and_b32 v146, v18, v6
  v_and_b32 v147, v18, v7
  s_waitcnt vmcnt(7)
  s_nop 0
  v_mfma_f32_16x16x32_bf16 v[152:155], v[144:147], v[136:139], v[152:155]
  s_waitcnt vmcnt(1)
  buffer_load_dwordx4 v[128:131], v36, s[44:47], s56 offen
  s_add_u32 s56, s56, 0x40000
  s_sub_u32 s57, s56, 0x500000
  s_min_u32 s56, s56, s57
  s_cmp_lg_u32 s61, 0
  s_cbranch_scc1 L_dr_13
  ds_read_b32 v15, v12 offset:0
  s_waitcnt lgkmcnt(0)
  v_readfirstlane_b32 s50, v15
  s_nop 0
  s_cmp_ge_u32 s50, s48
  s_cbranch_scc0 L_dr_13
  ds_read_b128 v[64:67], v8 offset:0
  ds_read_b128 v[68:71], v9 offset:0
  ds_read_b128 v[72:75], v10 offset:0
  ds_read_b128 v[76:79], v11 offset:0
  ds_read_b128 v[80:83], v8 offset:4096
  ds_read_b128 v[84:87], v9 offset:4096
  ds_read_b128 v[88:91], v10 offset:4096
  ds_read_b128 v[92:95], v11 offset:4096
  ds_read_b128 v[96:99], v8 offset:8192
  ds_read_b128 v[100:103], v9 offset:8192
  ds_read_b128 v[104:107], v10 offset:8192
  ds_read_b128 v[108:111], v11 offset:8192
  ds_read_b128 v[112:115], v8 offset:12288
  ds_read_b128 v[116:119], v9 offset:12288
  ds_read_b128 v[120:123], v10 offset:12288
  ds_read_b128 v[124:127], v11 offset:12288
  s_mov_b32 s61, 1
  s_waitcnt lgkmcnt(0)
  s_mov_b64 exec, 1
  ds_write_b32 v13, v162
  s_mov_b64 exec, -1
L_dr_13:
  v_and_b32 v148, v19, v4
  v_and_b32 v149, v19, v5
  v_and_b32 v150, v19, v6
  v_and_b32 v151, v19, v7
  s_waitcnt vmcnt(7)
  s_nop 0
  v_mfma_f32_16x16x32_bf16 v[152:155], v[148:151], v[140:143], v[152:155]
  s_waitcnt vmcnt(1)
  buffer_load_dwordx4 v[132:135], v36, s[44:47], s56 offen
  s_add_u32 s56, s56, 0x40000
  s_sub_u32 s57, s56, 0x500000
  s_min_u32 s56, s56, s57
  v_and_b32 v144, v20, v4
  v_and_b32 v145, v20, v5
  v_and_b32 v146, v20, v6
  v_and_b32 v147, v20, v7
  s_waitcnt vmcnt(7)
  s_nop 0
  v_mfma_f32_16x16x32_bf16 v[152:155], v[144:147], v[40:43], v[152:155]
  s_waitcnt vmcnt(1)
  buffer_load_dwordx4 v[136:139], v36, s[44:47], s56 offen
  s_add_u32 s56, s56, 0x40000
  s_sub_u32 s57, s56, 0x500000
  s_min_u32 s56, s56, s57
  v_and_b32 v148, v21, v4
  v_and_b32 v149, v21, v5
  v_and_b32 v150, v21, v6
  v_and_b32 v151, v21, v7
  s_waitcnt vmcnt(7)
  s_nop 0
  v_mfma_f32_16x16x32_bf16 v[152:155], v[148:151], v[44:47], v[152:155]
  s_waitcnt vmcnt(1)
  buffer_load_dwordx4 v[140:143], v36, s[44:47], s56 offen
  s_add_u32 s56, s56, 0x40000
  s_sub_u32 s57, s56, 0x500000
  s_min_u32 s56, s56, s57
  s_cmp_lg_u32 s61, 0
  s_cbranch_scc1 L_dr_14
  ds_read_b32 v15, v12 offset:0
  s_waitcnt lgkmcnt(0)
  v_readfirstlane_b32 s50, v15
  s_nop 0
  s_cmp_ge_u32 s50, s48
  s_cbranch_scc0 L_dr_14
  ds_read_b128 v[64:67], v8 offset:0
  ds_read_b128 v[68:71], v9 offset:0
  ds_read_b128 v[72:75], v10 offset:0
  ds_read_b128 v[76:79], v11 offset:0
  ds_read_b128 v[80:83], v8 offset:4096
  ds_read_b128 v[84:87], v9 offset:4096
  ds_read_b128 v[88:91], v10 offset:4096
  ds_read_b128 v[92:95], v11 offset:4096
  ds_read_b128 v[96:99], v8 offset:8192
  ds_read_b128 v[100:103], v9 offset:8192
  ds_read_b128 v[104:107], v10 offset:8192
  ds_read_b128 v[108:111], v11 offset:8192
  ds_read_b128 v[112:115], v8 offset:12288
  ds_read_b128 v[116:119], v9 offset:12288
  ds_read_b128 v[120:123], v10 offset:12288
  ds_read_b128 v[124:127], v11 offset:12288
  s_mov_b32 s61, 1
  s_waitcnt lgkmcnt(0)
  s_mov_b64 exec, 1
  ds_write_b32 v13, v162
  s_mov_b64 exec, -1
L_dr_14:
  v_and_b32 v144, v22, v4
  v_and_b32 v145, v22, v5
  v_and_b32 v146, v22, v6
  v_and_b32 v147, v22, v7
  s_waitcnt vmcnt(7)
  s_nop 0
  v_mfma_f32_16x16x32_bf16 v[152:155], v[144:147], v[48:51], v[152:155]
  s_waitcnt vmcnt(1)
  buffer_load_dwordx4 v[40:43], v36, s[44:47], s56 offen
  s_add_u32 s56, s56, 0x40000
  s_sub_u32 s57, s56, 0x500000
  s_min_u32 s56, s56, s57
  v_and_b32 v148, v23, v4
  v_and_b32 v149, v23, v5
  v_and_b32 v150, v23, v6
  v_and_b32 v151, v23, v7
  s_waitcnt vmcnt(7)
  s_nop 0
  v_mfma_f32_16x16x32_bf16 v[152:155], v[148:151], v[52:55], v[152:155]
  s_waitcnt vmcnt(1)
  buffer_load_dwordx4 v[44:47], v36, s[44:47], s56 offen
  s_add_u32 s56, s56, 0x40000
  s_sub_u32 s57, s56, 0x500000
  s_min_u32 s56, s56, s57
  v_and_b32 v144, v24, v4
  v_and_b32 v145, v24, v5
  v_and_b32 v146, v24, v6
  v_and_b32 v147, v24, v7
  s_waitcnt vmcnt(7)
  s_nop 0
  v_mfma_f32_16x16x32_bf16 v[152:155], v[144:147], v[56:59], v[152:155]
  s_waitcnt vmcnt(1)
  buffer_load_dwordx4 v[48:51], v36, s[44:47], s56 offen
  s_add_u32 s56, s56, 0x40000
  s_sub_u32 s57, s56, 0x500000
  s_min_u32 s56, s56, s57
  s_cmp_lg_u32 s61, 0
  s_cbranch_scc1 L_dr_15
  ds_read_b32 v15, v12 offset:0
  s_waitcnt lgkmcnt(0)
  v_readfirstlane_b32 s50, v15
  s_nop 0
  s_cmp_ge_u32 s50, s48
  s_cbranch_scc0 L_dr_15
  ds_read_b128 v[64:67], v8 offset:0
  ds_read_b128 v[68:71], v9 offset:0
  ds_read_b128 v[72:75], v10 offset:0
  ds_read_b128 v[76:79], v11 offset:0
  ds_read_b128 v[80:83], v8 offset:4096
  ds_read_b128 v[84:87], v9 offset:4096
  ds_read_b128 v[88:91], v10 offset:4096
  ds_read_b128 v[92:95], v11 offset:4096
  ds_read_b128 v[96:99], v8 offset:8192
  ds_read_b128 v[100:103], v9 offset:8192
  ds_read_b128 v[104:107], v10 offset:8192
  ds_read_b128 v[108:111], v11 offset:8192
  ds_read_b128 v[112:115], v8 offset:12288
  ds_read_b128 v[116:119], v9 offset:12288
  ds_read_b128 v[120:123], v10 offset:12288
  ds_read_b128 v[124:127], v11 offset:12288
  s_mov_b32 s61, 1
  s_waitcnt lgkmcnt(0)
  s_mov_b64 exec, 1
  ds_write_b32 v13, v162
  s_mov_b64 exec, -1
L_dr_15:
  v_and_b32 v148, v25, v4
  v_and_b32 v149, v25, v5
  v_and_b32 v150, v25, v6
  v_and_b32 v151, v25, v7
  s_waitcnt vmcnt(7)
  s_nop 0
  v_mfma_f32_16x16x32_bf16 v[152:155], v[148:151], v[60:63], v[152:155]
  s_waitcnt vmcnt(1)
  buffer_load_dwordx4 v[52:55], v36, s[44:47], s56 offen
  s_add_u32 s56, s56, 0x40000
  s_sub_u32 s57, s56, 0x500000
  s_min_u32 s56, s56, s57
  v_and_b32 v144, v26, v4
  v_and_b32 v145, v26, v5
  v_and_b32 v146, v26, v6
  v_and_b32 v147, v26, v7
  s_waitcnt vmcnt(7)
  s_nop 0
  v_mfma_f32_16x16x32_bf16 v[152:155], v[144:147], v[128:131], v[152:155]
  s_waitcnt vmcnt(1)
  buffer_load_dwordx4 v[56:59], v36, s[44:47], s56 offen
  s_add_u32 s56, s56, 0x40000
  s_sub_u32 s57, s56, 0x500000
  s_min_u32 s56, s56, s57
  v_and_b32 v148, v27, v4
  v_and_b32 v149, v27, v5
  v_and_b32 v150, v27, v6
  v_and_b32 v151, v27, v7
  s_waitcnt vmcnt(7)
  s_nop 0
  v_mfma_f32_16x16x32_bf16 v[152:155], v[148:151], v[132:135], v[152:155]
  s_waitcnt vmcnt(1)
  buffer_load_dwordx4 v[60:63], v36, s[44:47], s56 offen
  v_and_b32 v144, v28, v4
  v_and_b32 v145, v28, v5
  v_and_b32 v146, v28, v6
  v_and_b32 v147, v28, v7
  s_waitcnt vmcnt(7)
  s_nop 0
  v_mfma_f32_16x16x32_bf16 v[152:155], v[144:147], v[136:139], v[152:155]
  v_and_b32 v148, v29, v4
  v_and_b32 v149, v29, v5
  v_and_b32 v150, v29, v6
  v_and_b32 v151, v29, v7
  s_waitcnt vmcnt(6)
  s_nop 0
  v_mfma_f32_16x16x32_bf16 v[152:155], v[148:151], v[140:143], v[152:155]
  v_and_b32 v144, v30, v4
  v_and_b32 v145, v30, v5
  v_and_b32 v146, v30, v6
  v_and_b32 v147, v30, v7
  s_waitcnt vmcnt(5)
  s_nop 0
  v_mfma_f32_16x16x32_bf16 v[152:155], v[144:147], v[40:43], v[152:155]
  v_and_b32 v148, v31, v4
  v_and_b32 v149, v31, v5
  v_and_b32 v150, v31, v6
  v_and_b32 v151, v31, v7
  s_waitcnt vmcnt(4)
  s_nop 0
  v_mfma_f32_16x16x32_bf16 v[152:155], v[148:151], v[44:47], v[152:155]
  v_and_b32 v144, v32, v4
  v_and_b32 v145, v32, v5
  v_and_b32 v146, v32, v6
  v_and_b32 v147, v32, v7
  s_waitcnt vmcnt(3)
  s_nop 0
  v_mfma_f32_16x16x32_bf16 v[152:155], v[144:147], v[48:51], v[152:155]
  v_and_b32 v148, v33, v4
  v_and_b32 v149, v33, v5
  v_and_b32 v150, v33, v6
  v_and_b32 v151, v33, v7
  s_waitcnt vmcnt(2)
  s_nop 0
  v_mfma_f32_16x16x32_bf16 v[152:155], v[148:151], v[52:55], v[152:155]
  v_and_b32 v144, v34, v4
  v_and_b32 v145, v34, v5
  v_and_b32 v146, v34, v6
  v_and_b32 v147, v34, v7
  s_waitcnt vmcnt(1)
  s_nop 0
  v_mfma_f32_16x16x32_bf16 v[152:155], v[144:147], v[56:59], v[152:155]
  v_and_b32 v148, v35, v4
  v_and_b32 v149, v35, v5
  v_and_b32 v150, v35, v6
  v_and_b32 v151, v35, v7
  s_waitcnt vmcnt(0)
  s_nop 0
  v_mfma_f32_16x16x32_bf16 v[152:155], v[148:151], v[60:63], v[152:155]
  s_lshl_b32 s57, s35, 9
  s_add_u32 s57, s57, 147456
  v_lshlrev_b32 v36, 5, v3
  v_lshl_add_u32 v36, v2, 4, v36
  v_add_u32 v163, s57, v36
  s_mov_b32 exec_hi, 0
  s_nop 1
  ds_write_b128 v163, v[152:155]
  s_mov_b64 exec, -1
  s_waitcnt lgkmcnt(0)
  s_mov_b64 exec, 1
  ds_add_u32 v12, v162 offset:4
  s_mov_b64 exec, -1
L_bar0:
  s_cmp_lg_u32 s61, 0
  s_cbranch_scc1 L_dr_16
  ds_read_b32 v15, v12 offset:0
  s_waitcnt lgkmcnt(0)
  v_readfirstlane_b32 s50, v15
  s_nop 0
  s_cmp_ge_u32 s50, s48
  s_cbranch_scc0 L_dr_16
  ds_read_b128 v[64:67], v8 offset:0
  ds_read_b128 v[68:71], v9 offset:0
  ds_read_b128 v[72:75], v10 offset:0
  ds_read_b128 v[76:79], v11 offset:0
  ds_read_b128 v[80:83], v8 offset:4096
  ds_read_b128 v[84:87], v9 offset:4096
  ds_read_b128 v[88:91], v10 offset:4096
  ds_read_b128 v[92:95], v11 offset:4096
  ds_read_b128 v[96:99], v8 offset:8192
  ds_read_b128 v[100:103], v9 offset:8192
  ds_read_b128 v[104:107], v10 offset:8192
  ds_read_b128 v[108:111], v11 offset:8192
  ds_read_b128 v[112:115], v8 offset:12288
  ds_read_b128 v[116:119], v9 offset:12288
  ds_read_b128 v[120:123], v10 offset:12288
  ds_read_b128 v[124:127], v11 offset:12288
  s_mov_b32 s61, 1
  s_waitcnt lgkmcnt(0)
  s_mov_b64 exec, 1
  ds_write_b32 v13, v162
  s_mov_b64 exec, -1
L_dr_16:
  ds_read_b32 v15, v12 offset:4
  s_waitcnt lgkmcnt(0)
  v_readfirstlane_b32 s50, v15
  s_nop 0
  s_cmp_lt_u32 s50, 9
  s_cbranch_scc1 L_bar0
  s_mul_i32 s57, s35, 432
  v_lshl_add_u32 v38, v1, 3, s57
  v_cmp_gt_u32 vcc, 54, v1
  v_mov_b32 v39, 0x10000
  s_nop 0
  v_cndmask_b32 v38, v39, v38, vcc
  s_mov_b32 s42, 3456
  s_mov_b32 s40, s20
  s_mov_b32 s41, s21
  buffer_load_dwordx2 v[138:139], v38, s[40:43], 0 offen
  s_mov_b32 s46, 3456
  s_mov_b32 s44, s22
  s_mov_b32 s45, s23
  buffer_load_dwordx2 v[140:141], v38, s[44:47], 0 offen
  s_mov_b32 s74, 3456
  s_mov_b32 s72, s24
  s_mov_b32 s73, s25
  s_mov_b32 s75, 0x20000
  buffer_load_dwordx2 v[136:137], v38, s[72:75], 0 offen
  s_mul_i32 s57, s37, 80
  s_add_u32 s57, s57, 154112
  v_mov_b32 v157, s57
  s_lshl_b32 s57, s35, 8
  s_add_u32 s57, s57, 152064
  v_mov_b32 v158, s57
  v_lshlrev_b32 v37, 3, v1
  v_add_u32 v37, 147456, v37
  ds_read_b64 v[40:41], v37 offset:0
  ds_read_b64 v[42:43], v37 offset:512
  ds_read_b64 v[44:45], v37 offset:1024
  ds_read_b64 v[46:47], v37 offset:1536
  ds_read_b64 v[48:49], v37 offset:2048
  ds_read_b64 v[50:51], v37 offset:2560
  ds_read_b64 v[52:53], v37 offset:3072
  ds_read_b64 v[54:55], v37 offset:3584
  v_and_b32 v38, 48, v1
  v_and_b32 v39, 3, v1
  v_lshl_add_u32 v38, v39, 2, v38
  v_bfe_u32 v39, v1, 2, 2
  v_add_u32 v38, v38, v39
  s_lshl_b32 s57, s35, 11
  s_add_u32 s57, s57, 131072
  v_lshl_add_u32 v14, v38, 2, s57
  v_mov_b32 v156, 0xff800000
  v_mov_b32 v159, 0xbdd2d3e8
  s_waitcnt lgkmcnt(0)
  v_add_f32 v40, v40, v42
  v_add_f32 v41, v41, v43
  v_add_f32 v40, v40, v44
  v_add_f32 v41, v41, v45
  v_add_f32 v40, v40, v46
  v_add_f32 v41, v41, v47
  v_add_f32 v40, v40, v48
  v_add_f32 v41, v41, v49
  v_add_f32 v40, v40, v50
  v_add_f32 v41, v41, v51
  v_add_f32 v40, v40, v52
  v_add_f32 v41, v41, v53
  v_add_f32 v40, v40, v54
  v_add_f32 v41, v41, v55
  v_cvt_pk_bf16_f32 v40, v40, v41
  v_lshlrev_b32 v37, 2, v1
  v_add_u32 v37, 151552, v37
  ds_write_b32 v37, v40
  v_lshlrev_b32 v37, 4, v2
  v_add_u32 v37, 151552, v37
  s_waitcnt lgkmcnt(0)
  ds_read_b128 v[16:19], v37 offset:0
  ds_read_b128 v[20:23], v37 offset:64
  ds_read_b128 v[24:27], v37 offset:128
  ds_read_b128 v[28:31], v37 offset:192
  s_mov_b32 s49, 0
  s_mov_b32 s59, 0x3db504f3
  s_waitcnt lgkmcnt(0)
  s_cmp_lg_u32 s61, 0
  s_cbranch_scc1 L_k_mf
L_k:
L_wf_17:
  ds_read_b32 v15, v12 offset:0
  s_waitcnt lgkmcnt(0)
  v_readfirstlane_b32 s50, v15
  s_nop 0
  s_cmp_ge_u32 s50, s48
  s_cbranch_scc1 L_wfd_18
  s_sleep 1
  s_branch L_wf_17
L_wfd_18:
  ds_read_b128 v[64:67], v8 offset:0
  ds_read_b128 v[68:71], v9 offset:0
  ds_read_b128 v[72:75], v10 offset:0
  ds_read_b128 v[76:79], v11 offset:0
  ds_read_b128 v[80:83], v8 offset:4096
  ds_read_b128 v[84:87], v9 offset:4096
  ds_read_b128 v[88:91], v10 offset:4096
  ds_read_b128 v[92:95], v11 offset:4096
  ds_read_b128 v[96:99], v8 offset:8192
  ds_read_b128 v[100:103], v9 offset:8192
  ds_read_b128 v[104:107], v10 offset:8192
  ds_read_b128 v[108:111], v11 offset:8192
  ds_read_b128 v[112:115], v8 offset:12288
  ds_read_b128 v[116:119], v9 offset:12288
  ds_read_b128 v[120:123], v10 offset:12288
  ds_read_b128 v[124:127], v11 offset:12288
L_k_mf:
  s_waitcnt lgkmcnt(15)
  v_mfma_f32_16x16x32_bf16 v[32:35], v[16:19], v[64:67], 0
  s_waitcnt lgkmcnt(14)
  v_mfma_f32_16x16x32_bf16 v[32:35], v[20:23], v[68:71], v[32:35]
  s_waitcnt lgkmcnt(13)
  v_mfma_f32_16x16x32_bf16 v[32:35], v[24:27], v[72:75], v[32:35]
  s_waitcnt lgkmcnt(12)
  v_mfma_f32_16x16x32_bf16 v[32:35], v[28:31], v[76:79], v[32:35]
  s_waitcnt lgkmcnt(11)
  v_mfma_f32_16x16x32_bf16 v[36:39], v[16:19], v[80:83], 0
  s_waitcnt lgkmcnt(10)
  v_mfma_f32_16x16x32_bf16 v[36:39], v[20:23], v[84:87], v[36:39]
  s_waitcnt lgkmcnt(9)
  v_mfma_f32_16x16x32_bf16 v[36:39], v[24:27], v[88:91], v[36:39]
  s_waitcnt lgkmcnt(8)
  v_mfma_f32_16x16x32_bf16 v[36:39], v[28:31], v[92:95], v[36:39]
  s_waitcnt lgkmcnt(7)
  v_mfma_f32_16x16x32_bf16 v[40:43], v[16:19], v[96:99], 0
  s_waitcnt lgkmcnt(6)
  v_mfma_f32_16x16x32_bf16 v[40:43], v[20:23], v[100:103], v[40:43]
  s_waitcnt lgkmcnt(5)
  v_mfma_f32_16x16x32_bf16 v[40:43], v[24:27], v[104:107], v[40:43]
  s_waitcnt lgkmcnt(4)
  v_mfma_f32_16x16x32_bf16 v[40:43], v[28:31], v[108:111], v[40:43]
  s_waitcnt lgkmcnt(3)
  v_mfma_f32_16x16x32_bf16 v[44:47], v[16:19], v[112:115], 0
  s_waitcnt lgkmcnt(2)
  v_mfma_f32_16x16x32_bf16 v[44:47], v[20:23], v[116:119], v[44:47]
  s_waitcnt lgkmcnt(1)
  v_mfma_f32_16x16x32_bf16 v[44:47], v[24:27], v[120:123], v[44:47]
  s_waitcnt lgkmcnt(0)
  v_mfma_f32_16x16x32_bf16 v[44:47], v[28:31], v[124:127], v[44:47]
  s_add_u32 s50, s49, 1
  v_mov_b32 v160, s50
  s_mov_b64 exec, 1
  ds_write_b32 v13, v160
  s_mov_b64 exec, -1
  v_cndmask_b32 v160, v32, v36, s[66:67]
  v_cndmask_b32 v160, v160, v40, s[68:69]
  s_nop 0
  v_cndmask_b32 v160, v160, v44, s[70:71]
  v_cvt_pk_bf16_f32 v160, v160, v160
  v_and_b32 v160, 0xffff0000, v160
  v_mul_f32 v160, s59, v160
  v_cvt_pk_bf16_f32 v160, v160, v160
  v_and_b32 v160, 0xffff0000, v160
  v_max_f32 v156, v156, v160
  ds_write_b32 v14, v160
  v_add_u32 v14, 0x100, v14
  s_cmp_ge_u32 s49, 7
  s_cbranch_scc1 L_k_nogate
  ds_read_b32 v144, v157
  ds_read_b32 v145, v157 offset:4
  ds_read_b32 v146, v157 offset:8
  v_add_u32 v157, 12, v157
  s_cmp_lg_u32 s49, 0
  s_cbranch_scc1 L_k_gop
  s_waitcnt vmcnt(0)
  v_lshlrev_b32 v128, 16, v138
  v_and_b32 v129, 0xffff0000, v138
  v_lshlrev_b32 v132, 16, v140
  v_and_b32 v133, 0xffff0000, v140
  v_lshlrev_b32 v130, 16, v139
  v_and_b32 v131, 0xffff0000, v139
  v_lshlrev_b32 v134, 16, v141
  v_and_b32 v135, 0xffff0000, v141
L_k_gop:
  v_mov_b32 v148, 0
  v_mov_b32 v149, 0
  v_mov_b32 v150, 0
  s_waitcnt lgkmcnt(0)
  v_mul_f32 v48, v128, v144
  v_mul_f32 v49, v129, v144
  v_cvt_pk_bf16_f32 v48, v48, v49
  v_and_b32 v49, 0xffff0000, v48
  v_lshlrev_b32 v48, 16, v48
  v_add_f32 v48, v132, v48
  v_add_f32 v49, v133, v49
  v_cvt_pk_bf16_f32 v48, v48, v49
  v_and_b32 v49, 0xffff0000, v48
  v_lshlrev_b32 v48, 16, v48
  v_mul_f32 v50, v48, v48
  v_mul_f32 v51, v49, v49
  v_fmaak_f32 v50, v50, v159, 0xc0135761
  v_fmaak_f32 v51, v51, v159, 0xc0135761
  v_mul_f32 v50, v48, v50
  v_mul_f32 v51, v49, v51
  v_exp_f32 v50, v50
  v_exp_f32 v51, v51
  v_add_f32 v50, 1.0, v50
  v_add_f32 v51, 1.0, v51
  v_rcp_f32 v50, v50
  v_rcp_f32 v51, v51
  v_mul_f32 v48, v48, v50
  v_mul_f32 v49, v49, v51
  v_cvt_pk_bf16_f32 v48, v48, v49
  v_dot2c_f32_bf16 v148, v136, v48
  v_mul_f32 v56, v130, v144
  v_mul_f32 v57, v131, v144
  v_cvt_pk_bf16_f32 v56, v56, v57
  v_and_b32 v57, 0xffff0000, v56
  v_lshlrev_b32 v56, 16, v56
  v_add_f32 v56, v134, v56
  v_add_f32 v57, v135, v57
  v_cvt_pk_bf16_f32 v56, v56, v57
  v_and_b32 v57, 0xffff0000, v56
  v_lshlrev_b32 v56, 16, v56
  v_mul_f32 v58, v56, v56
  v_mul_f32 v59, v57, v57
  v_fmaak_f32 v58, v58, v159, 0xc0135761
  v_fmaak_f32 v59, v59, v159, 0xc0135761
  v_mul_f32 v58, v56, v58
  v_mul_f32 v59, v57, v59
  v_exp_f32 v58, v58
  v_exp_f32 v59, v59
  v_add_f32 v58, 1.0, v58
  v_add_f32 v59, 1.0, v59
  v_rcp_f32 v58, v58
  v_rcp_f32 v59, v59
  v_mul_f32 v56, v56, v58
  v_mul_f32 v57, v57, v59
  v_cvt_pk_bf16_f32 v56, v56, v57
  v_dot2c_f32_bf16 v148, v137, v56
  v_mul_f32 v48, v128, v145
  v_mul_f32 v49, v129, v145
  v_cvt_pk_bf16_f32 v48, v48, v49
  v_and_b32 v49, 0xffff0000, v48
  v_lshlrev_b32 v48, 16, v48
  v_add_f32 v48, v132, v48
  v_add_f32 v49, v133, v49
  v_cvt_pk_bf16_f32 v48, v48, v49
  v_and_b32 v49, 0xffff0000, v48
  v_lshlrev_b32 v48, 16, v48
  v_mul_f32 v50, v48, v48
  v_mul_f32 v51, v49, v49
  v_fmaak_f32 v50, v50, v159, 0xc0135761
  v_fmaak_f32 v51, v51, v159, 0xc0135761
  v_mul_f32 v50, v48, v50
  v_mul_f32 v51, v49, v51
  v_exp_f32 v50, v50
  v_exp_f32 v51, v51
  v_add_f32 v50, 1.0, v50
  v_add_f32 v51, 1.0, v51
  v_rcp_f32 v50, v50
  v_rcp_f32 v51, v51
  v_mul_f32 v48, v48, v50
  v_mul_f32 v49, v49, v51
  v_cvt_pk_bf16_f32 v48, v48, v49
  v_dot2c_f32_bf16 v149, v136, v48
  v_mul_f32 v56, v130, v145
  v_mul_f32 v57, v131, v145
  v_cvt_pk_bf16_f32 v56, v56, v57
  v_and_b32 v57, 0xffff0000, v56
  v_lshlrev_b32 v56, 16, v56
  v_add_f32 v56, v134, v56
  v_add_f32 v57, v135, v57
  v_cvt_pk_bf16_f32 v56, v56, v57
  v_and_b32 v57, 0xffff0000, v56
  v_lshlrev_b32 v56, 16, v56
  v_mul_f32 v58, v56, v56
  v_mul_f32 v59, v57, v57
  v_fmaak_f32 v58, v58, v159, 0xc0135761
  v_fmaak_f32 v59, v59, v159, 0xc0135761
  v_mul_f32 v58, v56, v58
  v_mul_f32 v59, v57, v59
  v_exp_f32 v58, v58
  v_exp_f32 v59, v59
  v_add_f32 v58, 1.0, v58
  v_add_f32 v59, 1.0, v59
  v_rcp_f32 v58, v58
  v_rcp_f32 v59, v59
  v_mul_f32 v56, v56, v58
  v_mul_f32 v57, v57, v59
  v_cvt_pk_bf16_f32 v56, v56, v57
  v_dot2c_f32_bf16 v149, v137, v56
  v_mul_f32 v48, v128, v146
  v_mul_f32 v49, v129, v146
  v_cvt_pk_bf16_f32 v48, v48, v49
  v_and_b32 v49, 0xffff0000, v48
  v_lshlrev_b32 v48, 16, v48
  v_add_f32 v48, v132, v48
  v_add_f32 v49, v133, v49
  v_cvt_pk_bf16_f32 v48, v48, v49
  v_and_b32 v49, 0xffff0000, v48
  v_lshlrev_b32 v48, 16, v48
  v_mul_f32 v50, v48, v48
  v_mul_f32 v51, v49, v49
  v_fmaak_f32 v50, v50, v159, 0xc0135761
  v_fmaak_f32 v51, v51, v159, 0xc0135761
  v_mul_f32 v50, v48, v50
  v_mul_f32 v51, v49, v51
  v_exp_f32 v50, v50
  v_exp_f32 v51, v51
  v_add_f32 v50, 1.0, v50
  v_add_f32 v51, 1.0, v51
  v_rcp_f32 v50, v50
  v_rcp_f32 v51, v51
  v_mul_f32 v48, v48, v50
  v_mul_f32 v49, v49, v51
  v_cvt_pk_bf16_f32 v48, v48, v49
  v_dot2c_f32_bf16 v150, v136, v48
  v_mul_f32 v56, v130, v146
  v_mul_f32 v57, v131, v146
  v_cvt_pk_bf16_f32 v56, v56, v57
  v_and_b32 v57, 0xffff0000, v56
  v_lshlrev_b32 v56, 16, v56
  v_add_f32 v56, v134, v56
  v_add_f32 v57, v135, v57
  v_cvt_pk_bf16_f32 v56, v56, v57
  v_and_b32 v57, 0xffff0000, v56
  v_lshlrev_b32 v56, 16, v56
  v_mul_f32 v58, v56, v56
  v_mul_f32 v59, v57, v57
  v_fmaak_f32 v58, v58, v159, 0xc0135761
  v_fmaak_f32 v59, v59, v159, 0xc0135761
  v_mul_f32 v58, v56, v58
  v_mul_f32 v59, v57, v59
  v_exp_f32 v58, v58
  v_exp_f32 v59, v59
  v_add_f32 v58, 1.0, v58
  v_add_f32 v59, 1.0, v59
  v_rcp_f32 v58, v58
  v_rcp_f32 v59, v59
  v_mul_f32 v56, v56, v58
  v_mul_f32 v57, v57, v59
  v_cvt_pk_bf16_f32 v56, v56, v57
  v_dot2c_f32_bf16 v150, v137, v56
  v_add_f32_dpp v148, v148, v148 quad_perm:[1,0,3,2] row_mask:0xf bank_mask:0xf
  v_add_f32_dpp v149, v149, v149 quad_perm:[1,0,3,2] row_mask:0xf bank_mask:0xf
  s_nop 0
  v_add_f32_dpp v150, v150, v150 quad_perm:[1,0,3,2] row_mask:0xf bank_mask:0xf
  v_add_f32_dpp v148, v148, v148 quad_perm:[2,3,0,1] row_mask:0xf bank_mask:0xf
  v_add_f32_dpp v149, v149, v149 quad_perm:[2,3,0,1] row_mask:0xf bank_mask:0xf
  v_add_f32_dpp v150, v150, v150 quad_perm:[2,3,0,1] row_mask:0xf bank_mask:0xf
  v_add_f32_dpp v148, v148, v148 row_half_mirror row_mask:0xf bank_mask:0xf
  v_add_f32_dpp v149, v149, v149 row_half_mirror row_mask:0xf bank_mask:0xf
  v_add_f32_dpp v150, v150, v150 row_half_mirror row_mask:0xf bank_mask:0xf
  v_add_f32_dpp v148, v148, v148 row_mirror row_mask:0xf bank_mask:0xf
  v_add_f32_dpp v149, v149, v149 row_mirror row_mask:0xf bank_mask:0xf
  v_add_f32_dpp v150, v150, v150 row_mirror row_mask:0xf bank_mask:0xf
  v_add_f32_dpp v148, v148, v148 row_bcast:15 row_mask:0xa bank_mask:0xf
  v_add_f32_dpp v149, v149, v149 row_bcast:15 row_mask:0xa bank_mask:0xf
  v_add_f32_dpp v150, v150, v150 row_bcast:15 row_mask:0xa bank_mask:0xf
  v_add_f32_dpp v148, v148, v148 row_bcast:31 row_mask:0xc bank_mask:0xf
  v_add_f32_dpp v149, v149, v149 row_bcast:31 row_mask:0xc bank_mask:0xf
  v_add_f32_dpp v150, v150, v150 row_bcast:31 row_mask:0xc bank_mask:0xf
  s_mov_b32 exec_lo, 0
  s_brev_b32 exec_hi, 1
  ds_write_b32 v158, v148
  ds_write_b32 v158, v149 offset:4
  ds_write_b32 v158, v150 offset:8
  s_mov_b64 exec, -1
  v_add_u32 v158, 12, v158
L_k_nogate:
  s_add_u32 s49, s49, 1
  s_add_u32 s48, s48, 32
  s_cmp_lt_u32 s49, 8
  s_cbranch_scc1 L_k
  s_lshl_b32 s57, s35, 11
  s_add_u32 s57, s57, 131072
  v_lshl_add_u32 v37, v1, 5, s57
  s_waitcnt lgkmcnt(0)
  ds_read_b128 v[40:43], v37
  ds_read_b128 v[44:47], v37 offset:16
  v_max_f32_dpp v156, v156, v156 quad_perm:[1,0,3,2] row_mask:0xf bank_mask:0xf
  s_nop 1
  v_max_f32_dpp v156, v156, v156 quad_perm:[2,3,0,1] row_mask:0xf bank_mask:0xf
  s_nop 1
  v_max_f32_dpp v156, v156, v156 row_half_mirror row_mask:0xf bank_mask:0xf
  s_nop 1
  v_max_f32_dpp v156, v156, v156 row_mirror row_mask:0xf bank_mask:0xf
  s_nop 1
  v_max_f32_dpp v156, v156, v156 row_bcast:15 row_mask:0xa bank_mask:0xf
  s_nop 1
  v_max_f32_dpp v156, v156, v156 row_bcast:31 row_mask:0xc bank_mask:0xf
  s_nop 0
  v_readlane_b32 s58, v156, 63
  s_mov_b32 s59, 0x3fb8aa3b
  s_waitcnt lgkmcnt(0)
  v_subrev_f32 v40, s58, v40
  v_subrev_f32 v41, s58, v41
  v_subrev_f32 v42, s58, v42
  v_subrev_f32 v43, s58, v43
  v_subrev_f32 v44, s58, v44
  v_subrev_f32 v45, s58, v45
  v_subrev_f32 v46, s58, v46
  v_subrev_f32 v47, s58, v47
  v_mul_f32 v40, s59, v40
  v_mul_f32 v41, s59, v41
  v_mul_f32 v42, s59, v42
  v_mul_f32 v43, s59, v43
  v_mul_f32 v44, s59, v44
  v_mul_f32 v45, s59, v45
  v_mul_f32 v46, s59, v46
  v_mul_f32 v47, s59, v47
  v_exp_f32 v40, v40
  v_exp_f32 v41, v41
  v_exp_f32 v42, v42
  v_exp_f32 v43, v43
  v_exp_f32 v44, v44
  v_exp_f32 v45, v45
  v_exp_f32 v46, v46
  v_exp_f32 v47, v47
  v_add_f32 v48, v40, v41
  v_add_f32 v48, v48, v42
  v_add_f32 v48, v48, v43
  v_add_f32 v48, v48, v44
  v_add_f32 v48, v48, v45
  v_add_f32 v48, v48, v46
  v_add_f32 v48, v48, v47
  s_nop 1
  v_add_f32_dpp v48, v48, v48 quad_perm:[1,0,3,2] row_mask:0xf bank_mask:0xf
  s_nop 1
  v_add_f32_dpp v48, v48, v48 quad_perm:[2,3,0,1] row_mask:0xf bank_mask:0xf
  s_nop 1
  v_add_f32_dpp v48, v48, v48 row_half_mirror row_mask:0xf bank_mask:0xf
  s_nop 1
  v_add_f32_dpp v48, v48, v48 row_mirror row_mask:0xf bank_mask:0xf
  s_nop 1
  v_add_f32_dpp v48, v48, v48 row_bcast:15 row_mask:0xa bank_mask:0xf
  s_nop 1
  v_add_f32_dpp v48, v48, v48 row_bcast:31 row_mask:0xc bank_mask:0xf
  s_nop 0
  v_readlane_b32 s56, v48, 63
  v_mov_b32 v50, s58
  s_nop 0
  v_mov_b32 v51, s56
  s_lshl_b32 s57, s35, 3
  s_add_u32 s57, s57, 151936
  v_mov_b32 v49, s57
  s_mov_b64 exec, 1
  ds_write_b64 v49, v[50:51]
  s_mov_b64 exec, -1
  s_waitcnt lgkmcnt(0)
  s_mov_b64 exec, 1
  ds_add_u32 v12, v162 offset:8
  s_mov_b64 exec, -1
L_bar_19:
  ds_read_b32 v15, v12 offset:8
  s_waitcnt lgkmcnt(0)
  v_readfirstlane_b32 s50, v15
  s_nop 0
  s_cmp_lt_u32 s50, 8
  s_cbranch_scc1 L_bar_19
  v_and_b32 v49, 7, v1
  v_lshlrev_b32 v49, 3, v49
  v_add_u32 v49, 151936, v49
  ds_read_b64 v[50:51], v49
  s_waitcnt lgkmcnt(0)
  v_mov_b32 v52, v50
  s_nop 1
  v_max_f32_dpp v52, v52, v52 quad_perm:[1,0,3,2] row_mask:0xf bank_mask:0xf
  s_nop 1
  v_max_f32_dpp v52, v52, v52 quad_perm:[2,3,0,1] row_mask:0xf bank_mask:0xf
  s_nop 1
  v_max_f32_dpp v52, v52, v52 row_half_mirror row_mask:0xf bank_mask:0xf
  v_sub_f32 v50, v50, v52
  v_mul_f32 v50, s59, v50
  v_exp_f32 v50, v50
  s_nop 0
  v_mul_f32 v50, v50, v51
  s_nop 1
  v_add_f32_dpp v50, v50, v50 quad_perm:[1,0,3,2] row_mask:0xf bank_mask:0xf
  s_nop 1
  v_add_f32_dpp v50, v50, v50 quad_perm:[2,3,0,1] row_mask:0xf bank_mask:0xf
  s_nop 1
  v_add_f32_dpp v50, v50, v50 row_half_mirror row_mask:0xf bank_mask:0xf
  v_sub_f32 v52, s58, v52
  v_mul_f32 v52, s59, v52
  v_exp_f32 v52, v52
  v_rcp_f32 v50, v50
  s_nop 0
  v_mul_f32 v52, v52, v50
  v_mul_f32 v40, v40, v52
  v_mul_f32 v41, v41, v52
  v_mul_f32 v42, v42, v52
  v_mul_f32 v43, v43, v52
  v_mul_f32 v44, v44, v52
  v_mul_f32 v45, v45, v52
  v_mul_f32 v46, v46, v52
  v_mul_f32 v47, v47, v52
  v_cvt_pk_bf16_f32 v40, v40, v40
  v_cvt_pk_bf16_f32 v41, v41, v41
  v_cvt_pk_bf16_f32 v42, v42, v42
  v_cvt_pk_bf16_f32 v43, v43, v43
  v_cvt_pk_bf16_f32 v44, v44, v44
  v_cvt_pk_bf16_f32 v45, v45, v45
  v_cvt_pk_bf16_f32 v46, v46, v46
  v_cvt_pk_bf16_f32 v47, v47, v47
  ds_write_b128 v37, v[40:43]
  ds_write_b128 v37, v[44:47] offset:16
  s_mov_b32 s40, s32
  s_mov_b32 s41, s33
  s_mov_b32 s42, 1310720
  s_mov_b32 s44, s16
  s_mov_b32 s45, s17
  s_mov_b32 s46, 5242880
  s_lshl_b32 s57, s35, 14
  v_xor_b32 v38, v2, v3
  v_lshlrev_b32 v38, 4, v38
  v_lshl_add_u32 v38, v2, 8, v38
  v_add_u32 v8, s57, v38
  v_xor_b32 v9, 0x440, v8
  v_xor_b32 v10, 0x880, v8
  v_xor_b32 v11, 0xcc0, v8
  s_lshl_b32 s57, s35, 11
  s_add_u32 s57, s57, 131072
  v_lshl_add_u32 v14, v2, 4, s57
  v_mov_b32 v152, 0
  v_mov_b32 v153, 0
  v_mov_b32 v154, 0
  v_mov_b32 v155, 0
  s_mov_b32 s49, 0
  v_mul_u32_u24 v157, 5120, v2
  v_lshl_add_u32 v157, v3, 4, v157
  s_lshl_b32 s55, s37, 7
  s_lshl_b32 s56, s35, 4
  s_add_u32 s55, s55, s56
  s_mul_i32 s55, s55, 1280
  s_add_u32 s54, s55, 3840
  s_mul_i32 s61, s36, 1
  s_cmp_ge_u32 s61, 7
  s_cselect_b32 s61, 0, s61
L_v:
  s_cmp_lg_u32 s61, 0
  s_cbranch_scc1 L_v_wo0
  buffer_load_dwordx4 v[64:67], v157, s[44:47], s55 offen offset:0
  buffer_load_dwordx4 v[68:71], v157, s[44:47], s55 offen offset:256
  buffer_load_dwordx4 v[72:75], v157, s[44:47], s55 offen offset:512
  s_branch L_v_nowo
L_v_wo0:
  s_cmp_lg_u32 s61, 1
  s_cbranch_scc1 L_v_wo1
  buffer_load_dwordx4 v[76:79], v157, s[44:47], s55 offen offset:768
  buffer_load_dwordx4 v[80:83], v157, s[44:47], s55 offen offset:1024
  buffer_load_dwordx4 v[84:87], v157, s[44:47], s55 offen offset:1280
  s_branch L_v_nowo
L_v_wo1:
  s_cmp_lg_u32 s61, 2
  s_cbranch_scc1 L_v_wo2
  buffer_load_dwordx4 v[88:91], v157, s[44:47], s55 offen offset:1536
  buffer_load_dwordx4 v[92:95], v157, s[44:47], s55 offen offset:1792
  buffer_load_dwordx4 v[96:99], v157, s[44:47], s55 offen offset:2048
  s_branch L_v_nowo
L_v_wo2:
  s_cmp_lg_u32 s61, 3
  s_cbranch_scc1 L_v_wo3
  buffer_load_dwordx4 v[100:103], v157, s[44:47], s55 offen offset:2304
  buffer_load_dwordx4 v[104:107], v157, s[44:47], s55 offen offset:2560
  buffer_load_dwordx4 v[108:111], v157, s[44:47], s55 offen offset:2816
  s_branch L_v_nowo
L_v_wo3:
  s_cmp_lg_u32 s61, 4
  s_cbranch_scc1 L_v_wo4
  buffer_load_dwordx4 v[112:115], v157, s[44:47], s55 offen offset:3072
  buffer_load_dwordx4 v[116:119], v157, s[44:47], s55 offen offset:3328
  buffer_load_dwordx4 v[120:123], v157, s[44:47], s55 offen offset:3584
  s_branch L_v_nowo
L_v_wo4:
  s_cmp_lg_u32 s61, 5
  s_cbranch_scc1 L_v_wo5
  buffer_load_dwordx4 v[124:127], v157, s[44:47], s54 offen offset:0
  buffer_load_dwordx4 v[128:131], v157, s[44:47], s54 offen offset:256
  buffer_load_dwordx4 v[132:135], v157, s[44:47], s54 offen offset:512
  s_branch L_v_nowo
L_v_wo5:
  buffer_load_dwordx4 v[136:139], v157, s[44:47], s54 offen offset:768
  buffer_load_dwordx4 v[140:143], v157, s[44:47], s54 offen offset:1024
L_v_wo6:
L_v_nowo:
  s_add_u32 s61, s61, 1
  s_cmp_ge_u32 s61, 7
  s_cselect_b32 s61, 0, s61
  ds_read_b128 v[16:19], v14 offset:0
  ds_read_b128 v[20:23], v14 offset:64
  ds_read_b128 v[24:27], v14 offset:128
  ds_read_b128 v[28:31], v14 offset:192
L_wf_20:
  ds_read_b32 v15, v12 offset:0
  s_waitcnt lgkmcnt(0)
  v_readfirstlane_b32 s50, v15
  s_nop 0
  s_cmp_ge_u32 s50, s48
  s_cbranch_scc1 L_wfd_21
  s_sleep 1
  s_branch L_wf_20
L_wfd_21:
  ds_read_b128 v[32:35], v8 offset:0
  ds_read_b128 v[36:39], v9 offset:0
  ds_read_b128 v[40:43], v10 offset:0
  ds_read_b128 v[44:47], v11 offset:0
  ds_read_b128 v[48:51], v8 offset:4096
  ds_read_b128 v[52:55], v9 offset:4096
  ds_read_b128 v[56:59], v10 offset:4096
  ds_read_b128 v[60:63], v11 offset:4096
  v_and_b32 v144, v16, v4
  v_and_b32 v145, v16, v5
  v_and_b32 v146, v16, v6
  v_and_b32 v147, v16, v7
  s_waitcnt lgkmcnt(7)
  s_nop 0
  v_mfma_f32_16x16x32_bf16 v[152:155], v[144:147], v[32:35], v[152:155]
  ds_read_b128 v[32:35], v8 offset:8192
  v_and_b32 v148, v17, v4
  v_and_b32 v149, v17, v5
  v_and_b32 v150, v17, v6
  v_and_b32 v151, v17, v7
  s_waitcnt lgkmcnt(7)
  s_nop 0
  v_mfma_f32_16x16x32_bf16 v[152:155], v[148:151], v[36:39], v[152:155]
  ds_read_b128 v[36:39], v9 offset:8192
  v_and_b32 v144, v18, v4
  v_and_b32 v145, v18, v5
  v_and_b32 v146, v18, v6
  v_and_b32 v147, v18, v7
  s_waitcnt lgkmcnt(7)
  s_nop 0
  v_mfma_f32_16x16x32_bf16 v[152:155], v[144:147], v[40:43], v[152:155]
  ds_read_b128 v[40:43], v10 offset:8192
  v_and_b32 v148, v19, v4
  v_and_b32 v149, v19, v5
  v_and_b32 v150, v19, v6
  v_and_b32 v151, v19, v7
  s_waitcnt lgkmcnt(7)
  s_nop 0
  v_mfma_f32_16x16x32_bf16 v[152:155], v[148:151], v[44:47], v[152:155]
  ds_read_b128 v[44:47], v11 offset:8192
  v_and_b32 v144, v20, v4
  v_and_b32 v145, v20, v5
  v_and_b32 v146, v20, v6
  v_and_b32 v147, v20, v7
  s_waitcnt lgkmcnt(7)
  s_nop 0
  v_mfma_f32_16x16x32_bf16 v[152:155], v[144:147], v[48:51], v[152:155]
  ds_read_b128 v[48:51], v8 offset:12288
  v_and_b32 v148, v21, v4
  v_and_b32 v149, v21, v5
  v_and_b32 v150, v21, v6
  v_and_b32 v151, v21, v7
  s_waitcnt lgkmcnt(7)
  s_nop 0
  v_mfma_f32_16x16x32_bf16 v[152:155], v[148:151], v[52:55], v[152:155]
  ds_read_b128 v[52:55], v9 offset:12288
  v_and_b32 v144, v22, v4
  v_and_b32 v145, v22, v5
  v_and_b32 v146, v22, v6
  v_and_b32 v147, v22, v7
  s_waitcnt lgkmcnt(7)
  s_nop 0
  v_mfma_f32_16x16x32_bf16 v[152:155], v[144:147], v[56:59], v[152:155]
  ds_read_b128 v[56:59], v10 offset:12288
  v_and_b32 v148, v23, v4
  v_and_b32 v149, v23, v5
  v_and_b32 v150, v23, v6
  v_and_b32 v151, v23, v7
  s_waitcnt lgkmcnt(7)
  s_nop 0
  v_mfma_f32_16x16x32_bf16 v[152:155], v[148:151], v[60:63], v[152:155]
  ds_read_b128 v[60:63], v11 offset:12288
  v_and_b32 v144, v24, v4
  v_and_b32 v145, v24, v5
  v_and_b32 v146, v24, v6
  v_and_b32 v147, v24, v7
  s_waitcnt lgkmcnt(7)
  s_nop 0
  v_mfma_f32_16x16x32_bf16 v[152:155], v[144:147], v[32:35], v[152:155]
  v_and_b32 v148, v25, v4
  v_and_b32 v149, v25, v5
  v_and_b32 v150, v25, v6
  v_and_b32 v151, v25, v7
  s_waitcnt lgkmcnt(6)
  s_nop 0
  v_mfma_f32_16x16x32_bf16 v[152:155], v[148:151], v[36:39], v[152:155]
  v_and_b32 v144, v26, v4
  v_and_b32 v145, v26, v5
  v_and_b32 v146, v26, v6
  v_and_b32 v147, v26, v7
  s_waitcnt lgkmcnt(5)
  s_nop 0
  v_mfma_f32_16x16x32_bf16 v[152:155], v[144:147], v[40:43], v[152:155]
  v_and_b32 v148, v27, v4
  v_and_b32 v149, v27, v5
  v_and_b32 v150, v27, v6
  v_and_b32 v151, v27, v7
  s_waitcnt lgkmcnt(4)
  s_nop 0
  v_mfma_f32_16x16x32_bf16 v[152:155], v[148:151], v[44:47], v[152:155]
  v_and_b32 v144, v28, v4
  v_and_b32 v145, v28, v5
  v_and_b32 v146, v28, v6
  v_and_b32 v147, v28, v7
  s_waitcnt lgkmcnt(3)
  s_nop 0
  v_mfma_f32_16x16x32_bf16 v[152:155], v[144:147], v[48:51], v[152:155]
  v_and_b32 v148, v29, v4
  v_and_b32 v149, v29, v5
  v_and_b32 v150, v29, v6
  v_and_b32 v151, v29, v7
  s_waitcnt lgkmcnt(2)
  s_nop 0
  v_mfma_f32_16x16x32_bf16 v[152:155], v[148:151], v[52:55], v[152:155]
  v_and_b32 v144, v30, v4
  v_and_b32 v145, v30, v5
  v_and_b32 v146, v30, v6
  v_and_b32 v147, v30, v7
  s_waitcnt lgkmcnt(1)
  s_nop 0
  v_mfma_f32_16x16x32_bf16 v[152:155], v[144:147], v[56:59], v[152:155]
  v_and_b32 v148, v31, v4
  v_and_b32 v149, v31, v5
  v_and_b32 v150, v31, v6
  v_and_b32 v151, v31, v7
  s_waitcnt lgkmcnt(0)
  s_nop 0
  v_mfma_f32_16x16x32_bf16 v[152:155], v[148:151], v[60:63], v[152:155]
  s_add_u32 s50, s49, 9
  v_mov_b32 v160, s50
  s_mov_b64 exec, 1
  ds_write_b32 v13, v160
  s_mov_b64 exec, -1
  v_add_u32 v14, 0x100, v14
  s_add_u32 s49, s49, 1
  s_add_u32 s48, s48, 32
  s_cmp_lt_u32 s49, 7
  s_cbranch_scc1 L_v
  ds_read_b128 v[16:19], v14 offset:0
  ds_read_b128 v[20:23], v14 offset:64
  ds_read_b128 v[24:27], v14 offset:128
  ds_read_b128 v[28:31], v14 offset:192
  s_sub_u32 s48, s48, 3
  s_mul_i32 s57, s35, 2080
  s_add_u32 s57, s57, 131072
  v_lshlrev_b32 v146, 5, v3
  v_lshl_add_u32 v146, v2, 4, v146
  v_add_u32 v144, s57, v146
  s_mul_i32 s57, s35, 2560
  v_add_u32 v146, s57, v146
  v_and_b32 v145, 7, v3
  v_mul_u32_u24 v145, 2080, v145
  v_lshl_add_u32 v145, v2, 4, v145
  s_lshl_b32 s57, s35, 6
  s_add_u32 s58, s57, 131072
  v_add_u32 v145, s58, v145
  v_add_u32 v151, s57, v1
  v_lshlrev_b32 v147, 3, v151
  v_lshlrev_b32 v148, 4, v151
  v_mul_u32_u24 v149, 0xcccd, v151
  v_lshrrev_b32 v149, 19, v149
  v_mul_u32_u24 v150, 10, v149
  v_sub_u32 v150, v151, v150
  v_mul_u32_u24 v149, 5120, v149
  v_lshl_add_u32 v149, v150, 4, v149
  v_add_u32 v150, 24576, v147
  s_mul_i32 s56, s38, 5120
  s_mul_i32 s54, s36, 163840
  s_mul_i32 s57, s37, 160
  s_add_u32 s54, s54, s57
  s_waitcnt lgkmcnt(0)
  v_and_b32 v48, v16, v4
  v_and_b32 v49, v16, v5
  v_and_b32 v50, v16, v6
  v_and_b32 v51, v16, v7
  v_and_b32 v52, v17, v4
  v_and_b32 v53, v17, v5
  v_and_b32 v54, v17, v6
  v_and_b32 v55, v17, v7
  v_and_b32 v56, v18, v4
  v_and_b32 v57, v18, v5
  v_and_b32 v58, v18, v6
  v_and_b32 v59, v18, v7
  v_and_b32 v60, v19, v4
  v_and_b32 v61, v19, v5
  v_and_b32 v62, v19, v6
  v_and_b32 v63, v19, v7
L_wf_22:
  ds_read_b32 v15, v12 offset:0
  s_waitcnt lgkmcnt(0)
  v_readfirstlane_b32 s50, v15
  s_nop 0
  s_cmp_ge_u32 s50, s48
  s_cbranch_scc1 L_wfd_23
  s_sleep 1
  s_branch L_wf_22
L_wfd_23:
  ds_read_b128 v[32:35], v8 offset:0
  ds_read_b128 v[36:39], v9 offset:0
  ds_read_b128 v[40:43], v10 offset:0
  ds_read_b128 v[44:47], v11 offset:0
  s_add_u32 s48, s48, 1
  s_waitcnt lgkmcnt(3)
  v_mfma_f32_16x16x32_bf16 v[152:155], v[48:51], v[32:35], v[152:155]
  s_waitcnt lgkmcnt(2)
  v_mfma_f32_16x16x32_bf16 v[152:155], v[52:55], v[36:39], v[152:155]
  s_waitcnt lgkmcnt(1)
  v_mfma_f32_16x16x32_bf16 v[152:155], v[56:59], v[40:43], v[152:155]
  s_waitcnt lgkmcnt(0)
  v_mfma_f32_16x16x32_bf16 v[152:155], v[60:63], v[44:47], v[152:155]
  v_and_b32 v48, v20, v4
  v_and_b32 v49, v20, v5
  v_and_b32 v50, v20, v6
  v_and_b32 v51, v20, v7
  v_and_b32 v52, v21, v4
  v_and_b32 v53, v21, v5
  v_and_b32 v54, v21, v6
  v_and_b32 v55, v21, v7
  v_and_b32 v56, v22, v4
  v_and_b32 v57, v22, v5
  v_and_b32 v58, v22, v6
  v_and_b32 v59, v22, v7
  v_and_b32 v60, v23, v4
  v_and_b32 v61, v23, v5
  v_and_b32 v62, v23, v6
  v_and_b32 v63, v23, v7
L_wf_24:
  ds_read_b32 v15, v12 offset:0
  s_waitcnt lgkmcnt(0)
  v_readfirstlane_b32 s50, v15
  s_nop 0
  s_cmp_ge_u32 s50, s48
  s_cbranch_scc0 L_wf_24
  ds_read_b128 v[32:35], v8 offset:4096
  ds_read_b128 v[36:39], v9 offset:4096
  ds_read_b128 v[40:43], v10 offset:4096
  ds_read_b128 v[44:47], v11 offset:4096
  s_add_u32 s48, s48, 1
  s_waitcnt lgkmcnt(3)
  v_mfma_f32_16x16x32_bf16 v[152:155], v[48:51], v[32:35], v[152:155]
  s_waitcnt lgkmcnt(2)
  v_mfma_f32_16x16x32_bf16 v[152:155], v[52:55], v[36:39], v[152:155]
  s_waitcnt lgkmcnt(1)
  v_mfma_f32_16x16x32_bf16 v[152:155], v[56:59], v[40:43], v[152:155]
  s_waitcnt lgkmcnt(0)
  v_mfma_f32_16x16x32_bf16 v[152:155], v[60:63], v[44:47], v[152:155]
  v_and_b32 v48, v24, v4
  v_and_b32 v49, v24, v5
  v_and_b32 v50, v24, v6
  v_and_b32 v51, v24, v7
  v_and_b32 v52, v25, v4
  v_and_b32 v53, v25, v5
  v_and_b32 v54, v25, v6
  v_and_b32 v55, v25, v7
  v_and_b32 v56, v26, v4
  v_and_b32 v57, v26, v5
  v_and_b32 v58, v26, v6
  v_and_b32 v59, v26, v7
  v_and_b32 v60, v27, v4
  v_and_b32 v61, v27, v5
  v_and_b32 v62, v27, v6
  v_and_b32 v63, v27, v7
L_wf_26:
  ds_read_b32 v15, v12 offset:0
  s_waitcnt lgkmcnt(0)
  v_readfirstlane_b32 s50, v15
  s_nop 0
  s_cmp_ge_u32 s50, s48
  s_cbranch_scc0 L_wf_26
  ds_read_b128 v[32:35], v8 offset:8192
  ds_read_b128 v[36:39], v9 offset:8192
  ds_read_b128 v[40:43], v10 offset:8192
  ds_read_b128 v[44:47], v11 offset:8192
  s_add_u32 s48, s48, 1
  s_waitcnt lgkmcnt(3)
  v_mfma_f32_16x16x32_bf16 v[152:155], v[48:51], v[32:35], v[152:155]
  s_waitcnt lgkmcnt(2)
  v_mfma_f32_16x16x32_bf16 v[152:155], v[52:55], v[36:39], v[152:155]
  s_waitcnt lgkmcnt(1)
  v_mfma_f32_16x16x32_bf16 v[152:155], v[56:59], v[40:43], v[152:155]
  s_waitcnt lgkmcnt(0)
  v_mfma_f32_16x16x32_bf16 v[152:155], v[60:63], v[44:47], v[152:155]
  v_and_b32 v48, v28, v4
  v_and_b32 v49, v28, v5
  v_and_b32 v50, v28, v6
  v_and_b32 v51, v28, v7
  v_and_b32 v52, v29, v4
  v_and_b32 v53, v29, v5
  v_and_b32 v54, v29, v6
  v_and_b32 v55, v29, v7
  v_and_b32 v56, v30, v4
  v_and_b32 v57, v30, v5
  v_and_b32 v58, v30, v6
  v_and_b32 v59, v30, v7
  v_and_b32 v60, v31, v4
  v_and_b32 v61, v31, v5
  v_and_b32 v62, v31, v6
  v_and_b32 v63, v31, v7
L_wf_28:
  ds_read_b32 v15, v12 offset:0
  s_waitcnt lgkmcnt(0)
  v_readfirstlane_b32 s50, v15
  s_nop 0
  s_cmp_ge_u32 s50, s48
  s_cbranch_scc0 L_wf_28
  ds_read_b128 v[32:35], v8 offset:12288
  ds_read_b128 v[36:39], v9 offset:12288
  ds_read_b128 v[40:43], v10 offset:12288
  ds_read_b128 v[44:47], v11 offset:12288
  s_add_u32 s48, s48, 1
  s_waitcnt lgkmcnt(3)
  v_mfma_f32_16x16x32_bf16 v[152:155], v[48:51], v[32:35], v[152:155]
  s_waitcnt lgkmcnt(2)
  v_mfma_f32_16x16x32_bf16 v[152:155], v[52:55], v[36:39], v[152:155]
  s_waitcnt lgkmcnt(1)
  v_mfma_f32_16x16x32_bf16 v[152:155], v[56:59], v[40:43], v[152:155]
  s_waitcnt lgkmcnt(0)
  v_mfma_f32_16x16x32_bf16 v[152:155], v[60:63], v[44:47], v[152:155]
  s_mov_b32 exec_hi, 0
  s_nop 6
  ds_write_b128 v144, v[152:155]
  s_mov_b64 exec, -1
  s_waitcnt vmcnt(0) lgkmcnt(0)
  s_barrier
  ds_read_b128 v[32:35], v145
  ds_read_b32 v160, v12 offset:12
  s_waitcnt lgkmcnt(0)
  v_add_f32_dpp v32, v32, v32 quad_perm:[1,0,3,2] row_mask:0xf bank_mask:0xf
  v_add_f32_dpp v33, v33, v33 quad_perm:[1,0,3,2] row_mask:0xf bank_mask:0xf
  v_add_f32_dpp v34, v34, v34 quad_perm:[1,0,3,2] row_mask:0xf bank_mask:0xf
  v_add_f32_dpp v35, v35, v35 quad_perm:[1,0,3,2] row_mask:0xf bank_mask:0xf
  v_add_f32_dpp v32, v32, v32 quad_perm:[2,3,0,1] row_mask:0xf bank_mask:0xf
  v_add_f32_dpp v33, v33, v33 quad_perm:[2,3,0,1] row_mask:0xf bank_mask:0xf
  v_add_f32_dpp v34, v34, v34 quad_perm:[2,3,0,1] row_mask:0xf bank_mask:0xf
  v_add_f32_dpp v35, v35, v35 quad_perm:[2,3,0,1] row_mask:0xf bank_mask:0xf
  v_add_f32_dpp v32, v32, v32 row_half_mirror row_mask:0xf bank_mask:0xf
  v_add_f32_dpp v33, v33, v33 row_half_mirror row_mask:0xf bank_mask:0xf
  v_add_f32_dpp v34, v34, v34 row_half_mirror row_mask:0xf bank_mask:0xf
  v_add_f32_dpp v35, v35, v35 row_half_mirror row_mask:0xf bank_mask:0xf
  v_cvt_pk_bf16_f32 v32, v32, v32
  v_cvt_pk_bf16_f32 v33, v33, v33
  v_cvt_pk_bf16_f32 v34, v34, v34
  v_cvt_pk_bf16_f32 v35, v35, v35
  v_and_b32 v16, v32, v4
  v_and_b32 v17, v32, v5
  v_and_b32 v18, v32, v6
  v_and_b32 v19, v32, v7
  v_and_b32 v20, v33, v4
  v_and_b32 v21, v33, v5
  v_and_b32 v22, v33, v6
  v_and_b32 v23, v33, v7
  v_and_b32 v24, v34, v4
  v_and_b32 v25, v34, v5
  v_and_b32 v26, v34, v6
  v_and_b32 v27, v34, v7
  v_and_b32 v28, v35, v4
  v_and_b32 v29, v35, v5
  v_and_b32 v30, v35, v6
  v_and_b32 v31, v35, v7
  v_mfma_f32_16x16x32_bf16 v[40:43], v[16:19], v[64:67], 0
  v_mfma_f32_16x16x32_bf16 v[40:43], v[20:23], v[84:87], v[40:43]
  v_mfma_f32_16x16x32_bf16 v[40:43], v[24:27], v[104:107], v[40:43]
  v_mfma_f32_16x16x32_bf16 v[40:43], v[28:31], v[124:127], v[40:43]
  v_mfma_f32_16x16x32_bf16 v[44:47], v[16:19], v[68:71], 0
  v_mfma_f32_16x16x32_bf16 v[44:47], v[20:23], v[88:91], v[44:47]
  v_mfma_f32_16x16x32_bf16 v[44:47], v[24:27], v[108:111], v[44:47]
  v_mfma_f32_16x16x32_bf16 v[44:47], v[28:31], v[128:131], v[44:47]
  v_mfma_f32_16x16x32_bf16 v[48:51], v[16:19], v[72:75], 0
  v_mfma_f32_16x16x32_bf16 v[48:51], v[20:23], v[92:95], v[48:51]
  v_mfma_f32_16x16x32_bf16 v[48:51], v[24:27], v[112:115], v[48:51]
  v_mfma_f32_16x16x32_bf16 v[48:51], v[28:31], v[132:135], v[48:51]
  s_mov_b32 exec_hi, 0
  ds_write_b128 v146, v[40:43] offset:0
  s_mov_b32 exec_hi, -1
  v_mfma_f32_16x16x32_bf16 v[52:55], v[16:19], v[76:79], 0
  v_mfma_f32_16x16x32_bf16 v[52:55], v[20:23], v[96:99], v[52:55]
  v_mfma_f32_16x16x32_bf16 v[52:55], v[24:27], v[116:119], v[52:55]
  v_mfma_f32_16x16x32_bf16 v[52:55], v[28:31], v[136:139], v[52:55]
  s_mov_b32 exec_hi, 0
  ds_write_b128 v146, v[44:47] offset:512
  s_mov_b32 exec_hi, -1
  v_mfma_f32_16x16x32_bf16 v[56:59], v[16:19], v[80:83], 0
  v_mfma_f32_16x16x32_bf16 v[56:59], v[20:23], v[100:103], v[56:59]
  v_mfma_f32_16x16x32_bf16 v[56:59], v[24:27], v[120:123], v[56:59]
  v_mfma_f32_16x16x32_bf16 v[56:59], v[28:31], v[140:143], v[56:59]
  s_mov_b32 exec_hi, 0
  ds_write_b128 v146, v[48:51] offset:1024
  s_mov_b32 exec_hi, -1
  v_readfirstlane_b32 s62, v160
  s_nop 0
  s_xor_b32 s63, s62, 2654435769
  s_mov_b32 exec_hi, 0
  ds_write_b128 v146, v[52:55] offset:1536
  s_mov_b32 exec_hi, -1
  s_mov_b32 exec_hi, 0
  ds_write_b128 v146, v[56:59] offset:2048
  s_mov_b32 exec_hi, -1
  v_mov_b32 v15, v147
  v_mov_b32 v13, v148
  v_mov_b32 v9, v149
  v_mov_b32 v11, v150
  s_waitcnt lgkmcnt(0)
  s_barrier
  s_cmp_ge_u32 s35, 5
  s_cbranch_scc1 L_nored
L_e2:
  ds_read_b64 v[32:33], v15 offset:0
  ds_read_b64 v[34:35], v15 offset:2560
  ds_read_b64 v[36:37], v15 offset:5120
  ds_read_b64 v[38:39], v15 offset:7680
  ds_read_b64 v[40:41], v15 offset:10240
  ds_read_b64 v[42:43], v15 offset:12800
  ds_read_b64 v[44:45], v15 offset:15360
  ds_read_b64 v[46:47], v15 offset:17920
  s_waitcnt lgkmcnt(6)
  v_add_f32 v32, v32, v34
  v_add_f32 v33, v33, v35
  s_waitcnt lgkmcnt(5)
  v_add_f32 v32, v32, v36
  v_add_f32 v33, v33, v37
  s_waitcnt lgkmcnt(4)
  v_add_f32 v32, v32, v38
  v_add_f32 v33, v33, v39
  s_waitcnt lgkmcnt(3)
  v_add_f32 v32, v32, v40
  v_add_f32 v33, v33, v41
  s_waitcnt lgkmcnt(2)
  v_add_f32 v32, v32, v42
  v_add_f32 v33, v33, v43
  s_waitcnt lgkmcnt(1)
  v_add_f32 v32, v32, v44
  v_add_f32 v33, v33, v45
  s_waitcnt lgkmcnt(0)
  v_add_f32 v32, v32, v46
  v_add_f32 v33, v33, v47
  v_xor_b32 v34, s62, v32
  v_xor_b32 v35, s63, v33
  buffer_store_dwordx4 v[32:35], v13, s[40:43], s56 offen sc1
  s_mov_b32 s65, 0
  s_waitcnt vmcnt(0)
L_ppoll:
  buffer_load_dwordx4 v[36:39], v9, s[40:43], s54 offen sc1
  s_waitcnt vmcnt(0)
  v_xor_b32 v38, v38, v36
  v_xor_b32 v39, v39, v37
  v_cmp_ne_u32 vcc, s62, v38
  v_cmp_ne_u32 s[72:73], s63, v39
  s_nop 0
  s_or_b64 vcc, vcc, s[72:73]
  s_and_b64 exec, exec, vcc
  s_cbranch_execz L_pdone
  s_add_u32 s65, s65, 1
  s_cmp_ge_u32 s65, 0x20000
  s_cbranch_scc1 L_pdone
  s_branch L_ppoll
L_pdone:
  s_mov_b64 exec, -1
  ds_write_b64 v11, v[36:37]
  s_waitcnt lgkmcnt(0)
  s_branch L_red_done
L_nored:
  s_cmp_lg_u32 s35, 5
  s_cbranch_scc1 L_red_done
L_e3:
  v_lshrrev_b32 v8, 3, v1
  v_min_u32 v8, 4, v8
  v_and_b32 v9, 7, v1
  v_mul_u32_u24 v10, 320, v9
  v_lshl_add_u32 v10, v8, 4, v10
  v_add_u32 v10, 24576, v10
  v_lshlrev_b32 v11, 4, v8
  v_add_u32 v11, 151552, v11
  ds_read_b128 v[48:51], v11
  ds_read_b128 v[52:55], v11 offset:128
  v_lshlrev_b32 v13, 3, v8
  s_mul_i32 s55, s36, 1280
  s_mul_i32 s57, s37, 40
  s_add_u32 s55, s55, s57
  s_mov_b32 s44, s28
  s_mov_b32 s45, s29
  s_mov_b32 s46, 10240
  s_waitcnt lgkmcnt(0)
L_red_done:
  s_barrier
  s_cmp_lg_u32 s35, 5
  s_cbranch_scc1 L_fin
L_e4:
  ds_read_b128 v[32:35], v10 offset:0
  ds_read_b128 v[36:39], v10 offset:80
  ds_read_b128 v[40:43], v10 offset:160
  ds_read_b128 v[44:47], v10 offset:240
  s_waitcnt lgkmcnt(2)
  v_add_f32 v32, v32, v36
  v_add_f32 v33, v33, v37
  v_add_f32 v34, v34, v38
  v_add_f32 v35, v35, v39
  s_waitcnt lgkmcnt(1)
  v_add_f32 v32, v32, v40
  v_add_f32 v33, v33, v41
  v_add_f32 v34, v34, v42
  v_add_f32 v35, v35, v43
  s_waitcnt lgkmcnt(0)
  v_add_f32 v32, v32, v44
  v_add_f32 v33, v33, v45
  v_add_f32 v34, v34, v46
  v_add_f32 v35, v35, v47
  v_add_f32_dpp v32, v32, v32 quad_perm:[1,0,3,2] row_mask:0xf bank_mask:0xf
  v_add_f32_dpp v33, v33, v33 quad_perm:[1,0,3,2] row_mask:0xf bank_mask:0xf
  v_add_f32_dpp v34, v34, v34 quad_perm:[1,0,3,2] row_mask:0xf bank_mask:0xf
  v_add_f32_dpp v35, v35, v35 quad_perm:[1,0,3,2] row_mask:0xf bank_mask:0xf
  v_add_f32_dpp v32, v32, v32 quad_perm:[2,3,0,1] row_mask:0xf bank_mask:0xf
  v_add_f32_dpp v33, v33, v33 quad_perm:[2,3,0,1] row_mask:0xf bank_mask:0xf
  v_add_f32_dpp v34, v34, v34 quad_perm:[2,3,0,1] row_mask:0xf bank_mask:0xf
  v_add_f32_dpp v35, v35, v35 quad_perm:[2,3,0,1] row_mask:0xf bank_mask:0xf
  v_add_f32_dpp v32, v32, v32 row_half_mirror row_mask:0xf bank_mask:0xf
  v_add_f32_dpp v33, v33, v33 row_half_mirror row_mask:0xf bank_mask:0xf
  v_add_f32_dpp v34, v34, v34 row_half_mirror row_mask:0xf bank_mask:0xf
  v_add_f32_dpp v35, v35, v35 row_half_mirror row_mask:0xf bank_mask:0xf
  v_cvt_pk_bf16_f32 v32, v32, v33
  v_and_b32 v33, 0xffff0000, v32
  v_lshlrev_b32 v32, 16, v32
  v_mul_f32 v32, v32, v48
  v_mul_f32 v33, v33, v49
  v_cvt_pk_bf16_f32 v32, v32, v33
  v_and_b32 v33, 0xffff0000, v32
  v_lshlrev_b32 v32, 16, v32
  v_add_f32 v32, v32, v52
  v_add_f32 v33, v33, v53
  v_cvt_pk_bf16_f32 v36, v32, v33
  v_cvt_pk_bf16_f32 v34, v34, v35
  v_and_b32 v35, 0xffff0000, v34
  v_lshlrev_b32 v34, 16, v34
  v_mul_f32 v34, v34, v50
  v_mul_f32 v35, v35, v51
  v_cvt_pk_bf16_f32 v34, v34, v35
  v_and_b32 v35, 0xffff0000, v34
  v_lshlrev_b32 v34, 16, v34
  v_add_f32 v34, v34, v54
  v_add_f32 v35, v35, v55
  v_cvt_pk_bf16_f32 v37, v34, v35
  s_mov_b32 exec_lo, 0x01010101
  s_mov_b32 exec_hi, 1
  buffer_store_dwordx2 v[36:37], v13, s[44:47], s55 offen
L_fin:
L_end:
  s_endpgm
.section .rodata,"a"
.p2align 6
.amdhsa_kernel recurrent_scan__gqa_block_cached__mixer_token_mlp__decode_kernel
  .amdhsa_next_free_vgpr 164
  .amdhsa_next_free_sgpr 102
  .amdhsa_accum_offset 164
  .amdhsa_group_segment_fixed_size 0
  .amdhsa_kernarg_size 104
  .amdhsa_user_sgpr_count 2
  .amdhsa_user_sgpr_kernarg_segment_ptr 1
  .amdhsa_system_sgpr_workgroup_id_x 1
  .amdhsa_float_denorm_mode_32 3
.end_amdhsa_kernel
```
